```python
import torch

def _softmax(x, axis=-1):
    return torch.softmax(x, dim=axis)
def _gelu(x):
    return torch.nn.functional.gelu(x, approximate="tanh")
def _silu(x):
    return torch.nn.functional.silu(x)
def _sigmoid(x):
    return torch.sigmoid(x)
def _layernorm(x, axis=-1, eps=1e-5):
    m = x.mean(dim=axis, keepdim=True)
    v = x.var(dim=axis, keepdim=True, unbiased=False)
    return (x - m) / torch.sqrt(v + eps)
def _scatter_add(tgt, idx, src, axis=0):
    return tgt.clone().index_add_(axis, idx, src)
def _segment_sum(src, seg, n):
    out = torch.zeros((n,) + src.shape[1:], dtype=src.dtype)
    return out.index_add_(0, seg, src)
def _pad(x, pw):
    flat = tuple(v for pair in reversed(pw) for v in pair)
    return torch.nn.functional.pad(x, flat)

kernel_name = 'standalone__paged_block_table_kv_pagedattention__sampling'

def setup_inputs():

    _w = (lambda a: (lambda t: t.to(torch.bfloat16) if t.is_floating_point() else t)(torch.as_tensor(a)))
    B, Hq, Hkv, Sq, Skv, D = 8, 32, 8, 8, 4096, 128
    bs = 16
    nbps = max(1, Skv // bs)
    num_phys = B * nbps + 4
    bt = torch.randperm(num_phys)[: B * nbps].reshape(B, nbps).to(torch.int64)
    cl = (nbps * bs - (torch.arange(1, B + 1, dtype=torch.int64) * 2654435761) % max(1, nbps * bs // 2)).to(torch.int64)
    return {
        "q": _w((lambda *s: torch.randn(*s, dtype=torch.bfloat16) * 0.8)(B, Hq, Sq, D)),
        "k_cache": _w((lambda *s: torch.randn(*s, dtype=torch.bfloat16) * 0.8)(num_phys, bs, Hkv, D)),
        "v_cache": _w((lambda *s: torch.randn(*s, dtype=torch.bfloat16) * 0.05)(num_phys, bs, Hkv, D)),
        "block_table": _w(bt),
        "context_lens": _w(cl),
    }

def reference(q, k_cache, v_cache, block_table, context_lens):
    B, Hq, Sq, D = q.shape
    bs = k_cache.shape[1]
    Hkv = k_cache.shape[2]
    nbps = block_table.shape[1]
    Skv = nbps * bs
    bt = block_table.reshape(-1)
    k = (lambda x, *d: x.permute(*d))(k_cache[bt].reshape(B, Skv, Hkv, D), 0, 2, 1, 3)
    v = (lambda x, *d: x.permute(*d))(v_cache[bt].reshape(B, Skv, Hkv, D), 0, 2, 1, 3)
    g = Hq // Hkv
    qg = q.reshape(B, Hkv, g, Sq, D)
    scores = torch.einsum("bhgqd,bhkd->bhgqk", qg, k) * (D ** -0.5)
    pos = torch.arange(Skv)
    msk = pos[None, :] < context_lens[:, None]
    scores = torch.where(msk[:, None, None, None, :], scores, -1e9)
    p = _softmax(scores, axis=-1)
    out = torch.einsum("bhgqk,bhkd->bhgqd", p, v)
    return out.reshape(B, Hq, Sq, D)
```

```asm
; @launch grid=(256,1,1) block=(384,1,1) lds=153984
.amdgcn_target "amdgcn-amd-amdhsa--gfx950"
.text
.globl standalone__paged_block_table_kv_pagedattention__sampling_kernel
.p2align 8
.type standalone__paged_block_table_kv_pagedattention__sampling_kernel,@function
standalone__paged_block_table_kv_pagedattention__sampling_kernel:
    s_load_dwordx16 s[4:19], s[0:1], 0
    s_cmp_ge_u32 s2, 256
    s_cbranch_scc1 L_end
    v_lshrrev_b32 v12, 6, v0
    v_and_b32 v1, 63, v0
    v_readfirstlane_b32 s3, v12
    s_and_b32 s44, s2, 7
    s_lshr_b32 s45, s2, 3
    s_cmp_ge_u32 s3, 2
    s_cbranch_scc1 L_cons
    s_setprio 3
    s_getpc_b64 s[28:29]
L_pc:
    v_lshrrev_b32 v12, 5, v1
    v_xor_b32 v3, s3, v12
    v_bfe_u32 v15, v1, 3, 1
    v_lshl_add_u32 v3, v15, 1, v3
    s_add_u32 s28, s28, plan_tab-L_pc
    s_addc_u32 s29, s29, 0
    s_lshl_b32 s58, s45, 5
    v_lshl_add_u32 v12, v3, 3, s58
    global_load_dwordx2 v[6:7], v12, s[28:29]
    s_lshr_b32 s58, s45, 2
    s_mov_b32 s59, 0x0
    s_cmp_ge_u32 s58, 1
    s_cselect_b32 s59, 0x77777770, s59
    s_cmp_ge_u32 s58, 2
    s_cselect_b32 s59, 0x11111111, s59
    s_cmp_ge_u32 s58, 3
    s_cselect_b32 s59, 0x66666666, s59
    s_cmp_ge_u32 s58, 4
    s_cselect_b32 s59, 0x55555555, s59
    s_cmp_ge_u32 s58, 5
    s_cselect_b32 s59, 0x22222225, s59
    s_cmp_ge_u32 s58, 6
    s_cselect_b32 s59, 0x44333333, s59
    s_cmp_ge_u32 s58, 7
    s_cselect_b32 s59, 0x44444444, s59
    s_and_b32 s58, s45, 3
    s_lshl_b32 s58, s58, 3
    s_lshr_b32 s59, s59, s58
    s_and_b32 s46, s59, 7
    s_bfe_u32 s47, s59, 0x30004
    v_lshlrev_b32 v2, 4, v1
    v_mov_b32 v13, 0
    v_lshlrev_b32 v26, 2, v1
    v_min_u32 v14, 60, v26
    v_add_u32 v14, 149504, v14
    ds_write_b32 v14, v13
    s_lshl_b32 s58, s46, 2
    s_lshl_b32 s59, s47, 2
    s_lshl_b32 s60, s46, 10
    s_lshl_b32 s61, s47, 10
    s_mov_b32 m0, 131072
    s_mov_b32 s34, 8192
    s_mov_b32 s35, 0x20000
    s_waitcnt lgkmcnt(0)
    s_load_dword s48, s[12:13], s58
    s_load_dword s49, s[12:13], s59
    s_mov_b32 s32, s10
    s_mov_b32 s33, s11
    buffer_load_dwordx4 v2, s[32:35], s60 offen lds
    s_mov_b32 m0, 132096
    s_sub_u32 s20, s6, 4096
    buffer_load_dwordx4 v2, s[32:35], s61 offen lds
    s_barrier
    s_subb_u32 s21, s7, 0
    s_mov_b32 s22, 67244032
    s_mov_b32 s23, 0x20000
    s_sub_u32 s24, s8, 4096
    s_subb_u32 s25, s9, 0
    s_mov_b32 s26, 67244032
    s_mov_b32 s27, 0x20000
    s_lshl_b32 s58, s44, 8
    v_and_b32 v16, 15, v1
    v_lshrrev_b32 v17, 4, v1
    v_xor_b32 v18, v17, v16
    v_lshl_add_u32 v19, v17, 11, s58
    v_lshl_add_u32 v20, v18, 4, v19
    v_xor_b32 v21, 64, v20
    v_xor_b32 v22, 128, v20
    v_xor_b32 v23, 192, v20
    v_lshlrev_b32 v18, 2, v17
    v_xor_b32 v18, v18, v16
    v_lshl_add_u32 v24, v18, 4, v19
    v_and_b32 v4, 7, v1
    v_and_b32 v5, 1, v17
    v_and_b32 v25, 3, v1
    v_lshlrev_b32 v25, 10, v25
    v_sub_u32 v25, 4096, v25
    v_lshlrev_b32 v29, 10, v15
    v_add_u32 v29, 131072, v29
    v_cmp_eq_u32 s[30:31], 0, v15
    v_lshlrev_b32 v32, 15, v3
    v_lshl_add_u32 v32, v5, 14, v32
    v_lshlrev_b32 v36, 2, v3
    v_add_u32 v34, 149520, v36
    v_add_u32 v36, 149504, v36
    v_add_u32 v26, 153728, v26
    v_mov_b32 v27, 67244032
    v_mov_b32 v35, 1
    v_mov_b32 v33, 0
    s_mov_b32 s54, 153728
    s_mov_b32 s55, 153728
    v_mov_b32 v43, v32
    v_mov_b32 v42, -1
    v_mov_b32 v44, v36
    s_mov_b32 s62, 0
    s_mov_b32 s63, 0
    s_mov_b32 s57, 0
    s_waitcnt lgkmcnt(0)
    s_sub_u32 s48, s48, 1
    s_min_u32 s48, s48, 0xfff
    s_sub_u32 s49, s49, 1
    s_min_u32 s49, s49, 0xfff
    v_mov_b32 v18, s49
    v_mov_b32 v19, s48
    v_cndmask_b32 v18, v18, v19, s[30:31]
    v_lshrrev_b32 v19, 2, v18
    v_add_u32 v19, 1, v19
    s_waitcnt vmcnt(2)
    v_mul_u32_u24 v8, v19, v6
    v_lshrrev_b32 v8, 16, v8
    v_add_u32 v50, v8, v4
    v_and_b32 v13, -4, v50
    v_add_u32 v13, v13, v29
    v_mul_u32_u24 v7, v19, v7
    v_lshrrev_b32 v7, 16, v7
    s_waitcnt vmcnt(0)
    ds_read_b32 v40, v13
    v_sub_u32 v19, v7, v8
    v_add_u32 v9, 7, v19
    v_lshrrev_b32 v9, 3, v9
    v_max_u32 v9, 1, v9
    v_lshlrev_b32 v10, 3, v9
    v_readlane_b32 s50, v9, 0
    v_readlane_b32 s58, v9, 8
    v_readlane_b32 s59, v9, 32
    v_readlane_b32 s60, v9, 40
    v_sub_u32 v10, v10, v19
    v_sub_u32 v28, v10, v9
    v_max_i32 v28, 0, v28
    s_max_u32 s50, s50, s58
    s_max_u32 s59, s59, s60
    s_max_u32 s50, s50, s59
    v_add_u32 v51, 1, v28
    v_sub_u32 v30, v9, v5
    v_min_u32 v51, v51, v10
    v_cmp_eq_u32 s[66:67], s50, v30
    v_sub_u32 v51, 8, v51
    v_and_b32 v50, 3, v50
    v_lshl_add_u32 v50, v50, 13, v25
    s_add_u32 s50, s50, 1
    s_waitcnt lgkmcnt(0)
    v_cmp_lt_u32 vcc, v4, v51
    v_min_u32 v40, 2052, v40
    v_cmp_eq_u32 s[68:69], 8, v51
    v_lshl_add_u32 v40, v40, 15, v50
    v_cndmask_b32 v40, v27, v40, vcc
    s_mov_b32 s64, s66
    s_mov_b32 s65, s68
L_round:
    v_readlane_b32 s72, v40, 0
    v_readlane_b32 s73, v40, 1
    v_readlane_b32 s74, v40, 2
    v_readlane_b32 s53, v43, 0
    s_bitcmp0_b32 s64, 0
    s_cbranch_scc1 L_skip0
    s_waitcnt lgkmcnt(0)
    v_cmp_lt_i32 vcc, v33, v42
    s_mov_b32 m0, s53
    s_bitcmp1_b32 vcc_lo, 0
    s_cbranch_scc1 L_st0
L_go0:
    ds_read_b32 v33, v34
    s_waitcnt vmcnt(10)
    buffer_load_dwordx4 v20, s[20:23], s72 offen offset:0 nt lds
    v_readlane_b32 s75, v40, 3
    s_waitcnt vmcnt(10)
    buffer_load_dwordx4 v21, s[20:23], s73 offen offset:1024 nt lds
    v_readlane_b32 s76, v40, 4
    s_waitcnt vmcnt(10)
    buffer_load_dwordx4 v22, s[20:23], s74 offen offset:2048 nt lds
    v_readlane_b32 s77, v40, 5
    s_waitcnt vmcnt(10)
    buffer_load_dwordx4 v23, s[20:23], s75 offen offset:3072 nt lds
    v_readlane_b32 s78, v40, 6
    s_add_u32 m0, s53, 4096
    v_writelane_b32 v26, s54, 0
    ds_add_u32 v26, v35
    s_mov_b32 s54, s55
    v_readlane_b32 s55, v44, 0
    s_waitcnt vmcnt(10)
    buffer_load_dwordx4 v20, s[20:23], s76 offen offset:0 nt lds
    v_readlane_b32 s79, v40, 7
    s_waitcnt vmcnt(10)
    buffer_load_dwordx4 v21, s[20:23], s77 offen offset:1024 nt lds
    s_waitcnt vmcnt(10)
    buffer_load_dwordx4 v22, s[20:23], s78 offen offset:2048 nt lds
    s_bitcmp0_b32 s65, 0
    s_cbranch_scc1 L_end0
    s_waitcnt vmcnt(10)
    buffer_load_dwordx4 v23, s[20:23], s79 offen offset:3072 nt lds
L_end0:
L_skip0:
    s_cmp_eq_u32 s62, 0
    s_cbranch_scc1 L_setup
L_setd:
    v_lshlrev_b32 v13, 3, v30
    v_min_u32 v12, v13, v28
    v_add_u32 v12, v12, v30
    v_min_u32 v12, v12, v10
    v_sub_u32 v13, v13, v12
    v_add3_u32 v50, v13, v8, v4
    v_and_b32 v13, -4, v50
    v_add_u32 v13, v13, v29
    ds_read_b32 v45, v13
    v_add3_u32 v14, v30, v28, 1
    v_min_u32 v14, v14, v10
    v_sub_u32 v12, v12, v14
    v_cmp_lt_u32 s[66:67], v30, v9
    v_add_u32 v51, 8, v12
    v_and_b32 v50, 3, v50
    v_lshl_add_u32 v50, v50, 13, v25
    v_readlane_b32 s72, v40, 8
    v_readlane_b32 s73, v40, 9
    v_readlane_b32 s74, v40, 10
    v_readlane_b32 s53, v43, 8
    s_bitcmp0_b32 s64, 8
    s_cbranch_scc1 L_skip1
    s_waitcnt lgkmcnt(0)
    v_cmp_lt_i32 vcc, v33, v42
    s_mov_b32 m0, s53
    s_bitcmp1_b32 vcc_lo, 8
    s_cbranch_scc1 L_st1
L_go1:
    ds_read_b32 v33, v34
    s_waitcnt vmcnt(10)
    buffer_load_dwordx4 v20, s[20:23], s72 offen offset:0 nt lds
    v_readlane_b32 s75, v40, 11
    s_waitcnt vmcnt(10)
    buffer_load_dwordx4 v21, s[20:23], s73 offen offset:1024 nt lds
    v_readlane_b32 s76, v40, 12
    s_waitcnt vmcnt(10)
    buffer_load_dwordx4 v22, s[20:23], s74 offen offset:2048 nt lds
    v_readlane_b32 s77, v40, 13
    s_waitcnt vmcnt(10)
    buffer_load_dwordx4 v23, s[20:23], s75 offen offset:3072 nt lds
    v_readlane_b32 s78, v40, 14
    s_add_u32 m0, s53, 4096
    v_writelane_b32 v26, s54, 0
    ds_add_u32 v26, v35
    s_mov_b32 s54, s55
    v_readlane_b32 s55, v44, 8
    s_waitcnt vmcnt(10)
    buffer_load_dwordx4 v20, s[20:23], s76 offen offset:0 nt lds
    v_readlane_b32 s79, v40, 15
    s_waitcnt vmcnt(10)
    buffer_load_dwordx4 v21, s[20:23], s77 offen offset:1024 nt lds
    s_waitcnt vmcnt(10)
    buffer_load_dwordx4 v22, s[20:23], s78 offen offset:2048 nt lds
    s_bitcmp0_b32 s65, 8
    s_cbranch_scc1 L_end1
    s_waitcnt vmcnt(10)
    buffer_load_dwordx4 v23, s[20:23], s79 offen offset:3072 nt lds
L_end1:
L_skip1:
    s_waitcnt lgkmcnt(0)
    v_cmp_lt_u32 vcc, v4, v51
    v_min_u32 v45, 2052, v45
    v_cmp_eq_u32 s[68:69], 8, v51
    v_lshl_add_u32 v45, v45, 15, v50
    v_cndmask_b32 v45, v27, v45, vcc
    v_readlane_b32 s72, v40, 16
    v_readlane_b32 s73, v40, 17
    v_readlane_b32 s74, v40, 18
    v_readlane_b32 s53, v43, 16
    s_bitcmp0_b32 s64, 16
    s_cbranch_scc1 L_skip2
    s_waitcnt lgkmcnt(0)
    v_cmp_lt_i32 vcc, v33, v42
    s_mov_b32 m0, s53
    s_bitcmp1_b32 vcc_lo, 16
    s_cbranch_scc1 L_st2
L_go2:
    ds_read_b32 v33, v34
    s_waitcnt vmcnt(10)
    buffer_load_dwordx4 v24, s[24:27], s72 offen offset:0 nt lds
    v_readlane_b32 s75, v40, 19
    s_waitcnt vmcnt(10)
    buffer_load_dwordx4 v24, s[24:27], s73 offen offset:1024 nt lds
    v_readlane_b32 s76, v40, 20
    s_waitcnt vmcnt(10)
    buffer_load_dwordx4 v24, s[24:27], s74 offen offset:2048 nt lds
    v_readlane_b32 s77, v40, 21
    s_waitcnt vmcnt(10)
    buffer_load_dwordx4 v24, s[24:27], s75 offen offset:3072 nt lds
    v_readlane_b32 s78, v40, 22
    s_add_u32 m0, s53, 4096
    v_writelane_b32 v26, s54, 0
    ds_add_u32 v26, v35
    s_mov_b32 s54, s55
    v_readlane_b32 s55, v44, 16
    s_waitcnt vmcnt(10)
    buffer_load_dwordx4 v24, s[24:27], s76 offen offset:0 nt lds
    v_readlane_b32 s79, v40, 23
    s_waitcnt vmcnt(10)
    buffer_load_dwordx4 v24, s[24:27], s77 offen offset:1024 nt lds
    s_waitcnt vmcnt(10)
    buffer_load_dwordx4 v24, s[24:27], s78 offen offset:2048 nt lds
    s_bitcmp0_b32 s65, 16
    s_cbranch_scc1 L_end2
    s_waitcnt vmcnt(10)
    buffer_load_dwordx4 v24, s[24:27], s79 offen offset:3072 nt lds
L_end2:
L_skip2:
    v_and_b32 v12, 1, v30
    v_lshl_add_u32 v48, v12, 13, v32
    v_mad_u32_u24 v12, v5, 3, v30
    v_add3_u32 v12, v12, v30, -3
    v_add_u32 v13, v5, v30
    v_max_i32 v47, v12, v13
    v_add_u32 v13, v13, v5
    v_cmp_ge_u32 vcc, v13, v9
    v_add_u32 v12, 32, v36
    v_add_u32 v30, 1, v30
    v_cndmask_b32 v49, v36, v12, vcc
    v_readlane_b32 s72, v40, 24
    v_readlane_b32 s73, v40, 25
    v_readlane_b32 s74, v40, 26
    v_readlane_b32 s53, v43, 24
    s_bitcmp0_b32 s64, 24
    s_cbranch_scc1 L_skip3
    s_waitcnt lgkmcnt(0)
    v_cmp_lt_i32 vcc, v33, v42
    s_mov_b32 m0, s53
    s_bitcmp1_b32 vcc_lo, 24
    s_cbranch_scc1 L_st3
L_go3:
    ds_read_b32 v33, v34
    s_waitcnt vmcnt(10)
    buffer_load_dwordx4 v24, s[24:27], s72 offen offset:0 nt lds
    v_readlane_b32 s75, v40, 27
    s_waitcnt vmcnt(10)
    buffer_load_dwordx4 v24, s[24:27], s73 offen offset:1024 nt lds
    v_readlane_b32 s76, v40, 28
    s_waitcnt vmcnt(10)
    buffer_load_dwordx4 v24, s[24:27], s74 offen offset:2048 nt lds
    v_readlane_b32 s77, v40, 29
    s_waitcnt vmcnt(10)
    buffer_load_dwordx4 v24, s[24:27], s75 offen offset:3072 nt lds
    v_readlane_b32 s78, v40, 30
    s_add_u32 m0, s53, 4096
    v_writelane_b32 v26, s54, 0
    ds_add_u32 v26, v35
    s_mov_b32 s54, s55
    v_readlane_b32 s55, v44, 24
    s_waitcnt vmcnt(10)
    buffer_load_dwordx4 v24, s[24:27], s76 offen offset:0 nt lds
    v_readlane_b32 s79, v40, 31
    s_waitcnt vmcnt(10)
    buffer_load_dwordx4 v24, s[24:27], s77 offen offset:1024 nt lds
    s_waitcnt vmcnt(10)
    buffer_load_dwordx4 v24, s[24:27], s78 offen offset:2048 nt lds
    s_bitcmp0_b32 s65, 24
    s_cbranch_scc1 L_end3
    s_waitcnt vmcnt(10)
    buffer_load_dwordx4 v24, s[24:27], s79 offen offset:3072 nt lds
L_end3:
L_skip3:
    v_mov_b32 v40, v45
    v_mov_b32 v42, v47
    v_mov_b32 v43, v48
    v_mov_b32 v44, v49
    s_mov_b32 s64, s66
    s_mov_b32 s65, s68
    s_sub_u32 s50, s50, 1
    s_cmp_lg_u32 s50, 0
    s_cbranch_scc1 L_round
    s_waitcnt vmcnt(7)
    v_writelane_b32 v26, s54, 0
    ds_add_u32 v26, v35
    s_waitcnt vmcnt(3)
    s_barrier
    s_waitcnt vmcnt(0)
    s_barrier
    s_waitcnt lgkmcnt(0)
    s_endpgm
L_setup:
    s_sub_u32 s58, s50, 2
    v_subrev_u32 v30, s58, v30
    v_add_u32 v18, 1, v18
    v_lshlrev_b32 v7, 2, v7
    v_min_u32 v7, v7, v18
    v_lshlrev_b32 v11, 2, v8
    v_sub_u32 v54, v7, v11
    v_lshlrev_b32 v18, 4, v3
    v_add_u32 v18, 149568, v18
    v_mov_b32 v52, v9
    v_mov_b32 v53, v10
    v_add_u32 v55, 1, v28
    ds_write_b128 v18, v[52:55]
    s_mov_b32 s62, 1
    s_branch L_setd
L_st0:
    s_mov_b32 s52, 0
    s_branch L_stall
L_st1:
    s_mov_b32 s52, 8
    s_branch L_stall
L_st2:
    s_mov_b32 s52, 16
    s_branch L_stall
L_st3:
    s_mov_b32 s52, 24
L_stall:
    ds_read_b32 v33, v34
    s_waitcnt lgkmcnt(0)
    v_cmp_lt_i32 vcc, v33, v42
    s_bitcmp0_b32 vcc_lo, s52
    s_cbranch_scc1 L_free
    s_waitcnt vmcnt(7)
    v_writelane_b32 v26, s54, 0
    ds_add_u32 v26, v35
    s_mov_b32 s54, 153728
    ds_read_b32 v33, v34
    s_waitcnt lgkmcnt(0)
    v_cmp_lt_i32 vcc, v33, v42
    s_bitcmp0_b32 vcc_lo, s52
    s_cbranch_scc1 L_free
    s_waitcnt vmcnt(0)
    v_writelane_b32 v26, s55, 0
    ds_add_u32 v26, v35
    s_mov_b32 s55, 153728
L_spin:
    ds_read_b32 v33, v34
    s_add_u32 s57, s57, 1
    s_waitcnt lgkmcnt(0)
    v_cmp_lt_i32 vcc, v33, v42
    s_cmp_gt_u32 s57, 0x200000
    s_cbranch_scc1 L_free
    s_bitcmp1_b32 vcc_lo, s52
    s_cbranch_scc1 L_spin
L_free:
    s_cmp_eq_u32 s52, 0
    s_cbranch_scc1 L_go0
    s_cmp_eq_u32 s52, 8
    s_cbranch_scc1 L_go1
    s_cmp_eq_u32 s52, 16
    s_cbranch_scc1 L_go2
    s_branch L_go3
L_cons:
    s_sub_u32 s3, s3, 2
    s_lshl_b32 s58, s3, 15
    v_lshlrev_b32 v29, 4, v1
    v_add_u32 v166, s58, v29
    s_lshl_b32 s46, s45, 2
    s_add_u32 s46, s46, s3
    s_mov_b32 s50, 0x4800
    s_cmp_ge_u32 s46, 18
    s_cselect_b32 s50, 0x3897, s50
    s_cmp_ge_u32 s46, 32
    s_cselect_b32 s50, 0x4101, s50
    s_cmp_ge_u32 s46, 48
    s_cselect_b32 s50, 0x4186, s50
    s_cmp_ge_u32 s46, 64
    s_cselect_b32 s50, 0x4a05, s50
    s_cmp_ge_u32 s46, 82
    s_cselect_b32 s50, 0x3a92, s50
    s_cmp_ge_u32 s46, 96
    s_cselect_b32 s50, 0x3303, s50
    s_cmp_ge_u32 s46, 108
    s_cselect_b32 s50, 0x5364, s50
    s_and_b32 s47, s50, 7
    s_bfe_u32 s85, s50, 0x70003
    s_lshr_b32 s49, s50, 10
    s_sub_u32 s48, s46, s85
    s_lshl_b32 s69, s47, 16
    s_lshl_b32 s60, s44, 13
    s_add_u32 s69, s69, s60
    s_lshr_b32 s65, s85, 2
    s_bfe_u32 s70, s85, 0x10001
    s_add_u32 s60, s85, s49
    s_sub_u32 s66, s60, 1
    s_lshr_b32 s66, s66, 2
    s_cmp_eq_u32 s66, s45
    s_cselect_b32 s67, s60, 0
    s_sub_u32 s66, s66, s65
    s_add_u32 s66, s66, 1
    s_cmp_eq_u32 s65, s45
    s_cselect_b32 s64, s70, 0
    s_bfe_u32 s67, s67, 0x10001
    s_or_b32 s67, s67, s64
    v_and_b32 v16, 15, v1
    v_lshrrev_b32 v17, 4, v1
    v_xor_b32 v18, v17, v16
    v_lshlrev_b32 v18, 4, v18
    v_lshl_add_u32 v25, v17, 8, v18
    s_and_b32 s79, s3, 1
    s_lshl_b32 s79, s79, 1
    s_lshr_b32 s63, s3, 1
    s_cmp_eq_u32 s67, 0
    s_cselect_b32 s79, s3, s79
    s_cselect_b32 s63, 0, s63
    s_lshl_b32 s63, s63, 13
    s_add_u32 s63, s63, 133120
    s_lshl_b32 s60, s79, 11
    s_add_u32 m0, s63, s60
    s_add_u32 s61, s69, s60
    s_lshl_b32 s60, s79, 7
    s_and_b32 s60, s60, 128
    v_xor_b32 v25, s60, v25
    v_xor_b32 v26, 64, v25
    v_xor_b32 v27, 128, v25
    v_xor_b32 v28, 192, v25
    s_mov_b32 s30, 524288
    s_mov_b32 s31, 0x20000
    s_lshl_b32 s62, s47, 2
    s_lshr_b32 s72, s69, 4
    s_add_u32 s72, s72, 0x500000
    v_mov_b32 v15, s72
    s_waitcnt lgkmcnt(0)
    s_barrier
    s_mov_b32 s28, s4
    s_mov_b32 s29, s5
    buffer_load_dwordx4 v25, s[28:31], s61 offen offset:0 nt lds
    buffer_load_dwordx4 v26, s[28:31], s61 offen offset:1024 nt lds
    s_cmp_eq_u32 s67, 0
    s_cbranch_scc1 L_qd
    buffer_load_dwordx4 v27, s[28:31], s61 offen offset:2048 nt lds
    buffer_load_dwordx4 v28, s[28:31], s61 offen offset:3072 nt lds
L_qd:
    global_load_dword v30, v15, s[18:19] sc1
    v_mov_b32 v192, 0
    v_mov_b32 v193, 0
    v_mov_b32 v194, 0
    v_mov_b32 v195, 0
    ds_write_b128 v166, v[192:195] offset:16384
    ds_write_b128 v166, v[192:195] offset:17408
    ds_write_b128 v166, v[192:195] offset:18432
    ds_write_b128 v166, v[192:195] offset:19456
    ds_write_b128 v166, v[192:195] offset:20480
    ds_write_b128 v166, v[192:195] offset:21504
    ds_write_b128 v166, v[192:195] offset:22528
    ds_write_b128 v166, v[192:195] offset:23552
    ds_write_b128 v166, v[192:195] offset:24576
    ds_write_b128 v166, v[192:195] offset:25600
    ds_write_b128 v166, v[192:195] offset:26624
    ds_write_b128 v166, v[192:195] offset:27648
    ds_write_b128 v166, v[192:195] offset:28672
    ds_write_b128 v166, v[192:195] offset:29696
    ds_write_b128 v166, v[192:195] offset:30720
    ds_write_b128 v166, v[192:195] offset:31744
    s_load_dword s51, s[12:13], s62
    s_mov_b32 s36, s18
    s_mov_b32 s37, s19
    s_mov_b32 s38, 268435456
    s_mov_b32 s39, 0x20000
    s_mov_b32 s40, s14
    s_mov_b32 s41, s15
    s_mov_b32 s42, 524288
    s_mov_b32 s43, 0x20000
    s_mov_b32 s71, 8192
    s_mov_b32 s57, 0x3e0293ee
    s_mov_b32 s82, 0
    s_mov_b32 s84, 0
    v_mov_b32 v6, 1
    v_mov_b32 v169, 149504
    s_lshl_b32 s60, s3, 2
    v_add_u32 v3, s60, v169
    s_mov_b64 exec, 1
    ds_write_b32 v3, v6 offset:16
    s_mov_b64 exec, -1
    v_lshrrev_b32 v18, 5, v1
    v_lshlrev_b32 v2, 2, v18
    v_xor_b32 v18, v18, v16
    v_lshlrev_b32 v18, 4, v18
    v_and_b32 v19, 31, v1
    v_lshl_add_u32 v18, v19, 8, v18
    v_add_u32 v32, s63, v18
    v_xor_b32 v33, 32, v32
    v_xor_b32 v34, 64, v32
    v_xor_b32 v35, 96, v32
    v_xor_b32 v36, 128, v32
    v_xor_b32 v37, 160, v32
    v_xor_b32 v38, 192, v32
    v_xor_b32 v39, 224, v32
    s_sub_u32 s54, s58, s63
    s_lshl_b32 s60, s45, 1
    s_add_u32 s64, s64, s60
    s_lshl_b32 s60, s44, 6
    s_add_u32 s64, s64, s60
    s_mul_i32 s64, s64, 10240
    s_lshl_b32 s65, s65, 1
    s_add_u32 s65, s65, s60
    s_mul_i32 s65, s65, 10240
    s_mul_i32 s70, s70, 10240
    s_mul_i32 s59, s79, 2560
    s_add_u32 s59, s59, s64
    s_xor_b32 s60, s3, 1
    s_and_b32 s61, s3, 2
    s_add_u32 s62, s61, 1
    s_add_u32 s88, s3, 1
    s_add_u32 s89, s3, 2
    s_add_u32 s90, s3, 3
    s_cmp_eq_u32 s67, 0
    s_cselect_b32 s88, s88, s3
    s_cselect_b32 s89, s89, s60
    s_cselect_b32 s90, s90, s60
    s_cselect_b32 s91, 8192, 0
    s_cselect_b32 s92, 0, 8192
    s_cselect_b32 s78, 1.0, 0.5
    s_cselect_b32 s93, 0, s61
    s_cselect_b32 s94, 1, s61
    s_cselect_b32 s95, 2, s62
    s_cselect_b32 s97, 3, s62
    s_and_b32 s88, s88, 3
    s_lshl_b32 s60, s88, 10
    s_add_u32 s60, s60, 149632
    v_add_u32 v163, s60, v29
    s_lshl_b32 s88, s88, 15
    v_add_u32 v160, s88, v29
    s_and_b32 s89, s89, 3
    s_lshl_b32 s60, s89, 10
    s_add_u32 s60, s60, 149632
    v_add_u32 v164, s60, v29
    s_lshl_b32 s89, s89, 15
    v_add_u32 v161, s89, v29
    s_and_b32 s90, s90, 3
    s_lshl_b32 s60, s90, 10
    s_add_u32 s60, s60, 149632
    v_add_u32 v165, s60, v29
    s_lshl_b32 s90, s90, 15
    v_add_u32 v162, s90, v29
    v_add_u32 v160, s91, v160
    v_add_u32 v161, 4096, v161
    v_add_u32 v162, s92, v162
    s_lshl_b32 s60, s3, 10
    s_add_u32 s60, s60, 149632
    v_add_u32 v22, s60, v29
    s_lshr_b32 s60, s85, 2
    s_sub_u32 s62, s45, s60
    s_bfe_u32 s60, s85, 0x10001
    s_sub_u32 s63, s62, s60
    s_add_u32 s24, s63, s3
    s_add_u32 s24, s24, s67
    s_cmp_lt_u32 s63, 4
    s_cselect_b32 s77, 1, 0
    s_lshl_b32 s60, s63, 5
    s_add_u32 s60, s60, s49
    s_cmp_eq_u32 s60, 12
    s_cselect_b32 s56, 1, 0
    s_cmp_eq_u32 s49, 14
    s_cselect_b32 s60, 1, 0
    s_cmp_eq_u32 s67, 0
    s_cselect_b32 s77, s77, s60
    s_cselect_b32 s56, s56, s60
    s_cselect_b32 s63, s63, 3
    s_lshl_b32 s60, s63, 3
    s_mul_i32 s61, s77, 0xff
    s_lshl_b32 s61, s61, s60
    s_mul_i32 s60, s56, 0xff000000
    s_or_b32 s61, s61, s60
    s_not_b32 s10, s61
    s_mov_b32 s11, s10
    s_lshl_b32 s56, s56, 1
    s_or_b32 s77, s77, s56
    s_mul_i32 s73, s79, 2560
    s_mul_i32 s60, s63, 640
    s_add_u32 s73, s73, s60
    s_lshl_b32 s60, s63, 7
    s_add_u32 s25, s58, s60
    s_lshl_b32 s60, s63, 5
    s_add_u32 s9, s58, s60
    s_lshl_b32 s8, s67, 12
    s_add_u32 s8, s8, s58
    s_add_u32 s8, s8, 384
    s_add_u32 s60, s79, s67
    s_mul_i32 s74, s60, 2560
    s_add_u32 s74, s74, 1920
    s_lshl_b32 s76, s60, 6
    s_add_u32 s76, s76, s69
    s_add_u32 s76, s76, 6144
    s_lshl_b32 s75, s63, 11
    s_lshl_b32 s60, s79, 6
    s_add_u32 s75, s75, s60
    s_add_u32 s75, s75, s69
    s_cmp_le_u32 s62, 0
    s_cselect_b32 s32, 2, 0
    s_mul_i32 s32, s32, 10240
    s_cmp_eq_u32 s62, 0
    s_cselect_b32 s60, 0, s70
    s_add_u32 s32, s32, s60
    s_add_u32 s32, s32, s65
    s_cmp_le_u32 s62, 1
    s_cselect_b32 s33, 4, 2
    s_mul_i32 s33, s33, 10240
    s_add_u32 s33, s33, s65
    s_cmp_le_u32 s62, 2
    s_cselect_b32 s34, 6, 4
    s_mul_i32 s34, s34, 10240
    s_add_u32 s34, s34, s65
    s_cmp_le_u32 s62, 3
    s_cselect_b32 s35, 8, 6
    s_mul_i32 s35, s35, 10240
    s_add_u32 s35, s35, s65
    s_lshl_b32 s80, s62, 2
    s_add_u32 s80, s80, s79
    s_lshl_b32 s80, s80, 2
    s_add_u32 s80, s80, s72
    s_mov_b32 s81, s62
    s_mov_b32 s56, 1
    v_and_b32 v18, 7, v1
    v_bfe_u32 v19, v1, 3, 1
    v_lshlrev_b32 v168, 8, v18
    v_lshl_add_u32 v168, v19, 3, v168
    v_lshl_add_u32 v168, v17, 4, v168
    v_lshrrev_b32 v18, 2, v16
    v_add_u32 v19, v2, v18
    v_lshlrev_b32 v19, 8, v19
    v_lshl_add_u32 v19, v18, 6, v19
    v_and_b32 v18, 1, v17
    v_lshl_add_u32 v19, v18, 5, v19
    v_and_b32 v18, 3, v1
    v_lshl_add_u32 v7, v18, 3, v19
    s_add_u32 s61, s58, 16384
    v_add_u32 v18, s61, v7
    s_add_u32 s60, s79, 0
    s_and_b32 s60, s60, 3
    s_lshl_b32 s60, s60, 6
    v_xor_b32 v40, s60, v18
    s_add_u32 s60, s79, 1
    s_and_b32 s60, s60, 3
    s_lshl_b32 s60, s60, 6
    v_xor_b32 v41, s60, v18
    s_add_u32 s60, s79, 2
    s_and_b32 s60, s60, 3
    s_lshl_b32 s60, s60, 6
    v_xor_b32 v42, s60, v18
    s_add_u32 s60, s79, 3
    s_and_b32 s60, s60, 3
    s_lshl_b32 s60, s60, 6
    v_xor_b32 v43, s60, v18
    s_lshl_b32 s60, s79, 6
    s_lshl_b32 s61, s67, 6
    s_add_u32 s61, s61, s60
    v_xor_b32 v18, s60, v7
    v_xor_b32 v19, s61, v7
    s_lshl_b32 s60, s93, 15
    s_add_u32 s61, s60, 16384
    v_add_u32 v60, s61, v18
    v_add_u32 v170, s60, v29
    s_lshl_b32 s60, s94, 15
    s_add_u32 s61, s60, 16384
    v_add_u32 v61, s61, v19
    v_add_u32 v171, s60, v29
    s_lshl_b32 s60, s95, 15
    s_add_u32 s61, s60, 16384
    v_add_u32 v62, s61, v18
    v_add_u32 v20, s60, v29
    s_lshl_b32 s60, s97, 15
    s_add_u32 s61, s60, 16384
    v_add_u32 v63, s61, v19
    v_add_u32 v21, s60, v29
    v_lshrrev_b32 v18, 2, v1
    v_and_b32 v18, 8, v18
    v_and_or_b32 v18, v1, 7, v18
    v_bfe_u32 v19, v1, 3, 2
    v_mul_u32_u24 v19, 640, v19
    v_lshl_add_u32 v0, v18, 4, v19
    v_lshl_add_u32 v7, v18, 3, v19
    v_mov_b32 v18, s32
    v_mov_b32 v19, s33
    v_cmp_le_u32 vcc, 1, v17
    s_nop 1
    v_cndmask_b32 v18, v18, v19, vcc
    v_mov_b32 v19, s34
    v_cmp_le_u32 vcc, 2, v17
    s_nop 1
    v_cndmask_b32 v18, v18, v19, vcc
    v_mov_b32 v19, s35
    v_cmp_le_u32 vcc, 3, v17
    s_nop 1
    v_cndmask_b32 v18, v18, v19, vcc
    s_sub_u32 s60, s66, 1
    v_mov_b32 v19, 0x10000000
    s_waitcnt lgkmcnt(0)
    v_cmp_gt_u32 s[12:13], s60, v17
    s_nop 1
    v_cndmask_b32 v18, v19, v18, s[12:13]
    v_lshl_add_u32 v167, v16, 4, v18
    v_mov_b32 v196, 0
    v_mov_b32 v197, 0
    v_mov_b32 v198, 0
    v_mov_b32 v199, 0
    v_mov_b32 v200, 0
    v_mov_b32 v201, 0
    v_mov_b32 v202, 0
    v_mov_b32 v203, 0
    v_mov_b32 v204, 0
    v_mov_b32 v205, 0
    v_mov_b32 v206, 0
    v_mov_b32 v207, 0
    v_mov_b32 v208, 0
    v_mov_b32 v209, 0
    v_mov_b32 v210, 0
    v_mov_b32 v211, 0
    v_mov_b32 v212, 0
    v_mov_b32 v213, 0
    v_mov_b32 v214, 0
    v_mov_b32 v215, 0
    v_mov_b32 v216, 0
    v_mov_b32 v217, 0
    v_mov_b32 v218, 0
    v_mov_b32 v219, 0
    v_mov_b32 v220, 0
    v_mov_b32 v221, 0
    v_mov_b32 v222, 0
    v_mov_b32 v223, 0
    v_mov_b32 v224, 0
    v_mov_b32 v225, 0
    v_mov_b32 v226, 0
    v_mov_b32 v227, 0
    v_mov_b32 v228, 0
    v_mov_b32 v229, 0
    v_mov_b32 v230, 0
    v_mov_b32 v231, 0
    v_mov_b32 v232, 0
    v_mov_b32 v233, 0
    v_mov_b32 v234, 0
    v_mov_b32 v235, 0
    v_mov_b32 v236, 0
    v_mov_b32 v237, 0
    v_mov_b32 v238, 0
    v_mov_b32 v239, 0
    v_mov_b32 v240, 0
    v_mov_b32 v241, 0
    v_mov_b32 v242, 0
    v_mov_b32 v243, 0
    v_mov_b32 v244, 0
    v_mov_b32 v245, 0
    v_mov_b32 v246, 0
    v_mov_b32 v247, 0
    v_mov_b32 v248, 0
    v_mov_b32 v249, 0
    v_mov_b32 v250, 0
    v_mov_b32 v251, 0
    v_mov_b32 v252, 0
    v_mov_b32 v253, 0
    v_mov_b32 v254, 0
    v_mov_b32 v255, 0
    v_mov_b32 v9, 0xf149f2ca
    v_mov_b32 v8, v9
    v_mov_b32 v64, 0
    v_mov_b32 v65, 0
    v_mov_b32 v66, 0
    v_mov_b32 v67, 0
    v_mov_b32 v68, 0
    v_mov_b32 v69, 0
    v_mov_b32 v70, 0
    v_mov_b32 v71, 0
    v_mov_b32 v72, 0
    v_mov_b32 v73, 0
    v_mov_b32 v74, 0
    v_mov_b32 v75, 0
    v_mov_b32 v76, 0
    v_mov_b32 v77, 0
    v_mov_b32 v78, 0
    v_mov_b32 v79, 0
    v_mov_b32 v10, 0
    v_mov_b32 v11, 0
    ds_write_b128 v22, v[192:195]
    s_waitcnt vmcnt(0)
    s_mov_b64 exec, 1
    ds_add_u32 v169, v6 offset:48
    s_mov_b64 exec, -1
    v_add_u32 v30, 1, v30
    s_getreg_b32 s46, hwreg(HW_REG_XCC_ID)
    s_cmp_lg_u32 s79, 0
    s_cbranch_scc1 L_nodie
    s_lshr_b32 s60, s85, 2
    s_sub_u32 s60, s45, s60
    s_lshl_b32 s60, s60, 3
    s_add_u32 s60, s60, s72
    v_mov_b32 v14, v30
    v_mov_b32 v15, s46
    v_mov_b32 v12, s60
    s_mov_b64 exec, 1
    global_store_dwordx2 v12, v[14:15], s[18:19] offset:128
    s_mov_b64 exec, -1
L_nodie:
L_w0:
    ds_read_b32 v4, v169 offset:48
    s_add_u32 s82, s82, 1
    s_waitcnt lgkmcnt(0)
    v_readfirstlane_b32 s83, v4
    s_cmp_ge_u32 s83, 4
    s_cbranch_scc1 L_wd0
    s_cmp_lt_u32 s82, 0x200000
    s_cbranch_scc1 L_w0
L_wd0:
    ds_read_b128 v[96:99], v32
    ds_read_b128 v[100:103], v33
    ds_read_b128 v[104:107], v34
    ds_read_b128 v[108:111], v35
    ds_read_b128 v[112:115], v36
    ds_read_b128 v[116:119], v37
    ds_read_b128 v[120:123], v38
    ds_read_b128 v[124:127], v39
    v_readfirstlane_b32 s68, v30
    s_waitcnt lgkmcnt(0)
    v_add_u32 v32, s54, v32
    v_add_u32 v33, s54, v33
    v_add_u32 v34, s54, v34
    v_add_u32 v35, s54, v35
    v_add_u32 v36, s54, v36
    v_add_u32 v37, s54, v37
    v_add_u32 v38, s54, v38
    v_add_u32 v39, s54, v39
    s_cmp_gt_i32 s51, 0
    s_cbranch_scc1 L_qok
    v_mov_b32 v96, 0
    v_mov_b32 v97, 0
    v_mov_b32 v98, 0
    v_mov_b32 v99, 0
    v_mov_b32 v100, 0
    v_mov_b32 v101, 0
    v_mov_b32 v102, 0
    v_mov_b32 v103, 0
    v_mov_b32 v104, 0
    v_mov_b32 v105, 0
    v_mov_b32 v106, 0
    v_mov_b32 v107, 0
    v_mov_b32 v108, 0
    v_mov_b32 v109, 0
    v_mov_b32 v110, 0
    v_mov_b32 v111, 0
    v_mov_b32 v112, 0
    v_mov_b32 v113, 0
    v_mov_b32 v114, 0
    v_mov_b32 v115, 0
    v_mov_b32 v116, 0
    v_mov_b32 v117, 0
    v_mov_b32 v118, 0
    v_mov_b32 v119, 0
    v_mov_b32 v120, 0
    v_mov_b32 v121, 0
    v_mov_b32 v122, 0
    v_mov_b32 v123, 0
    v_mov_b32 v124, 0
    v_mov_b32 v125, 0
    v_mov_b32 v126, 0
    v_mov_b32 v127, 0
L_qok:
L_w1:
    ds_read_b32 v4, v3 offset:0
    s_add_u32 s82, s82, 1
    s_waitcnt lgkmcnt(0)
    v_readfirstlane_b32 s83, v4
    s_cmp_ge_u32 s83, s56
    s_cbranch_scc1 L_wd1
    s_cmp_lt_u32 s82, 0x200000
    s_cbranch_scc1 L_w1
L_wd1:
    s_lshl_b32 s60, s3, 4
    v_add_u32 v18, s60, v169
    ds_read_b128 v[80:83], v18 offset:64
    s_lshl_b32 s60, s93, 4
    v_add_u32 v18, s60, v169
    ds_read_b32 v84, v18 offset:64
    s_lshl_b32 s60, s94, 4
    v_add_u32 v18, s60, v169
    ds_read_b32 v85, v18 offset:64
    s_lshl_b32 s60, s95, 4
    v_add_u32 v18, s60, v169
    ds_read_b32 v86, v18 offset:64
    s_lshl_b32 s60, s97, 4
    v_add_u32 v18, s60, v169
    ds_read_b32 v87, v18 offset:64
    s_waitcnt lgkmcnt(0)
    v_readfirstlane_b32 s52, v80
    v_readfirstlane_b32 s54, v81
    v_readfirstlane_b32 s53, v82
    v_readfirstlane_b32 s55, v83
    v_readfirstlane_b32 s20, v84
    v_and_b32 v84, 1, v84
    v_lshl_add_u32 v60, v84, 13, v60
    s_min_u32 s20, s20, 2
    s_lshl_b32 s60, s93, 2
    s_add_u32 s60, s60, 149536
    v_mov_b32 v17, s60
    v_mov_b32 v19, s20
    v_readfirstlane_b32 s21, v85
    v_and_b32 v85, 1, v85
    v_lshl_add_u32 v61, v85, 13, v61
    s_min_u32 s21, s21, 2
    s_lshl_b32 s60, s94, 2
    s_add_u32 s60, s60, 149536
    v_writelane_b32 v17, s60, 1
    v_writelane_b32 v19, s21, 1
    v_readfirstlane_b32 s22, v86
    v_and_b32 v86, 1, v86
    v_lshl_add_u32 v62, v86, 13, v62
    s_min_u32 s22, s22, 2
    s_lshl_b32 s60, s95, 2
    s_add_u32 s60, s60, 149536
    v_writelane_b32 v17, s60, 2
    v_writelane_b32 v19, s22, 2
    v_readfirstlane_b32 s23, v87
    v_and_b32 v87, 1, v87
    v_lshl_add_u32 v63, v87, 13, v63
    s_min_u32 s23, s23, 2
    s_lshl_b32 s60, s97, 2
    s_add_u32 s60, s60, 149536
    v_writelane_b32 v17, s60, 3
    v_writelane_b32 v19, s23, 3
    s_mov_b32 s60, 149560
    v_writelane_b32 v17, s60, 4
    v_writelane_b32 v19, 5, 4
L_loop:
    ds_read_b128 v[128:131], v32
    ds_read_b128 v[132:135], v33
    ds_read_b128 v[136:139], v34
    ds_read_b128 v[140:143], v35
    ds_read_b128 v[144:147], v36
    ds_read_b128 v[148:151], v37
    ds_read_b128 v[152:155], v38
    ds_read_b128 v[156:159], v39
    s_min_u32 s61, s54, s55
    s_mov_b32 s55, 1
    s_sub_u32 s54, s54, s61
    s_sub_u32 s61, 8, s61
    s_lshl_b32 s61, s61, 2
    s_min_i32 s60, s61, s53
    s_sub_u32 s53, s53, s61
    v_mov_b32 v23, v8
    s_cmp_lg_u32 s52, 1
    s_cbranch_scc1 L_keep
    v_mov_b32 v176, v64
    v_mov_b32 v177, v65
    v_mov_b32 v178, v66
    v_mov_b32 v179, v67
    v_mov_b32 v180, v68
    v_mov_b32 v181, v69
    v_mov_b32 v182, v70
    v_mov_b32 v183, v71
    v_mov_b32 v184, v72
    v_mov_b32 v185, v73
    v_mov_b32 v186, v74
    v_mov_b32 v187, v75
    v_mov_b32 v188, v76
    v_mov_b32 v189, v77
    v_mov_b32 v190, v78
    v_mov_b32 v191, v79
    s_sub_u32 s61, s66, 1
    v_min_u32 v13, s61, v1
    v_lshl_add_u32 v13, v13, 3, s72
    global_load_dwordx2 v[48:49], v13, s[18:19] offset:128 sc1
    s_waitcnt lgkmcnt(0)
    v_mfma_f32_32x32x16_bf16 v[64:79], v[128:131], v[96:99], 0
    ds_write_b128 v166, v[208:211] offset:0
    ds_write_b128 v166, v[212:215] offset:1024
    v_mfma_f32_32x32x16_bf16 v[64:79], v[132:135], v[100:103], v[64:79]
    ds_write_b128 v166, v[216:219] offset:2048
    v_mfma_f32_32x32x16_bf16 v[64:79], v[136:139], v[104:107], v[64:79]
    ds_write_b128 v166, v[220:223] offset:3072
    ds_write_b128 v166, v[224:227] offset:4096
    v_mfma_f32_32x32x16_bf16 v[64:79], v[140:143], v[108:111], v[64:79]
    ds_write_b128 v166, v[228:231] offset:5120
    v_mfma_f32_32x32x16_bf16 v[64:79], v[144:147], v[112:115], v[64:79]
    ds_write_b128 v166, v[232:235] offset:6144
    ds_write_b128 v166, v[236:239] offset:7168
    v_mfma_f32_32x32x16_bf16 v[64:79], v[148:151], v[116:119], v[64:79]
    ds_write_b128 v166, v[240:243] offset:8192
    v_mfma_f32_32x32x16_bf16 v[64:79], v[152:155], v[120:123], v[64:79]
    ds_write_b128 v166, v[244:247] offset:9216
    ds_write_b128 v166, v[248:251] offset:10240
    v_mfma_f32_32x32x16_bf16 v[64:79], v[156:159], v[124:127], v[64:79]
    ds_write_b128 v166, v[252:255] offset:11264
    s_branch L_qkd
L_keep:
    s_waitcnt lgkmcnt(7)
    v_mfma_f32_32x32x16_bf16 v[64:79], v[128:131], v[96:99], 0
    s_waitcnt lgkmcnt(6)
    v_mfma_f32_32x32x16_bf16 v[64:79], v[132:135], v[100:103], v[64:79]
    s_waitcnt lgkmcnt(5)
    v_mfma_f32_32x32x16_bf16 v[64:79], v[136:139], v[104:107], v[64:79]
    s_waitcnt lgkmcnt(4)
    v_mfma_f32_32x32x16_bf16 v[64:79], v[140:143], v[108:111], v[64:79]
    s_waitcnt lgkmcnt(3)
    v_mfma_f32_32x32x16_bf16 v[64:79], v[144:147], v[112:115], v[64:79]
    s_waitcnt lgkmcnt(2)
    v_mfma_f32_32x32x16_bf16 v[64:79], v[148:151], v[116:119], v[64:79]
    s_waitcnt lgkmcnt(1)
    v_mfma_f32_32x32x16_bf16 v[64:79], v[152:155], v[120:123], v[64:79]
    s_waitcnt lgkmcnt(0)
    v_mfma_f32_32x32x16_bf16 v[64:79], v[156:159], v[124:127], v[64:79]
    s_mov_b64 exec, 1
    ds_add_u32 v3, v6 offset:16
    s_mov_b64 exec, -1
L_qkd:
    v_xor_b32 v32, s71, v32
    v_xor_b32 v33, s71, v33
    v_xor_b32 v34, s71, v34
    v_xor_b32 v35, s71, v35
    v_xor_b32 v36, s71, v36
    v_xor_b32 v37, s71, v37
    v_xor_b32 v38, s71, v38
    v_xor_b32 v39, s71, v39
    s_cmp_ge_i32 s60, 32
    s_cbranch_scc1 L_nomask
    v_sub_u32 v12, s60, v2
    v_mov_b32 v13, 0xff800000
    s_cmp_ge_i32 s60, 24
    s_cbranch_scc1 L_mask3
    v_cmp_lt_i32 vcc, 0, v12
    v_cmp_lt_i32 s[86:87], 1, v12
    v_cmp_lt_i32 s[4:5], 2, v12
    v_cmp_lt_i32 s[6:7], 3, v12
    v_cndmask_b32 v64, v13, v64, vcc
    v_cndmask_b32 v65, v13, v65, s[86:87]
    v_cndmask_b32 v66, v13, v66, s[4:5]
    v_cndmask_b32 v67, v13, v67, s[6:7]
    v_cmp_lt_i32 vcc, 8, v12
    v_cmp_lt_i32 s[86:87], 9, v12
    v_cmp_lt_i32 s[4:5], 10, v12
    v_cmp_lt_i32 s[6:7], 11, v12
    v_cndmask_b32 v68, v13, v68, vcc
    v_cndmask_b32 v69, v13, v69, s[86:87]
    v_cndmask_b32 v70, v13, v70, s[4:5]
    v_cndmask_b32 v71, v13, v71, s[6:7]
    v_cmp_lt_i32 vcc, 16, v12
    v_cmp_lt_i32 s[86:87], 17, v12
    v_cmp_lt_i32 s[4:5], 18, v12
    v_cmp_lt_i32 s[6:7], 19, v12
    v_cndmask_b32 v72, v13, v72, vcc
    v_cndmask_b32 v73, v13, v73, s[86:87]
    v_cndmask_b32 v74, v13, v74, s[4:5]
    v_cndmask_b32 v75, v13, v75, s[6:7]
L_mask3:
    v_cmp_lt_i32 vcc, 24, v12
    v_cmp_lt_i32 s[86:87], 25, v12
    v_cmp_lt_i32 s[4:5], 26, v12
    v_cmp_lt_i32 s[6:7], 27, v12
    v_cndmask_b32 v76, v13, v76, vcc
    v_cndmask_b32 v77, v13, v77, s[86:87]
    v_cndmask_b32 v78, v13, v78, s[4:5]
    v_cndmask_b32 v79, v13, v79, s[6:7]
L_nomask:
    v_max3_f32 v12, v64, v65, v66
    v_max3_f32 v13, v67, v68, v69
    v_max3_f32 v14, v70, v71, v72
    v_max3_f32 v15, v73, v74, v75
    v_max3_f32 v16, v76, v77, v78
    v_max3_f32 v12, v12, v13, v79
    v_max3_f32 v14, v14, v15, v16
    v_max3_f32 v12, v12, v14, v9
    v_mov_b32 v13, v12
    v_mov_b32 v8, v9
    s_nop 0
    v_permlane32_swap_b32 v12, v13
    v_max_f32 v9, v12, v13
    v_sub_f32 v5, v8, v9
    v_mul_f32 v18, s57, v9
    v_mul_f32 v5, s57, v5
    v_exp_f32 v5, v5
    v_fma_f32 v64, v64, s57, -v18
    v_fma_f32 v65, v65, s57, -v18
    v_fma_f32 v66, v66, s57, -v18
    v_fma_f32 v67, v67, s57, -v18
    v_fma_f32 v68, v68, s57, -v18
    v_fma_f32 v69, v69, s57, -v18
    v_fma_f32 v70, v70, s57, -v18
    v_fma_f32 v71, v71, s57, -v18
    v_fma_f32 v72, v72, s57, -v18
    v_fma_f32 v73, v73, s57, -v18
    v_fma_f32 v74, v74, s57, -v18
    v_fma_f32 v75, v75, s57, -v18
    v_fma_f32 v76, v76, s57, -v18
    v_fma_f32 v77, v77, s57, -v18
    v_fma_f32 v78, v78, s57, -v18
    v_fma_f32 v79, v79, s57, -v18
    v_exp_f32 v64, v64
    v_exp_f32 v65, v65
    v_exp_f32 v66, v66
    v_exp_f32 v67, v67
    v_exp_f32 v68, v68
    v_exp_f32 v69, v69
    v_exp_f32 v70, v70
    v_exp_f32 v71, v71
    v_exp_f32 v72, v72
    v_exp_f32 v73, v73
    v_exp_f32 v74, v74
    v_exp_f32 v75, v75
    v_exp_f32 v76, v76
    v_exp_f32 v77, v77
    v_exp_f32 v78, v78
    v_exp_f32 v79, v79
    v_mul_f32 v10, v10, v5
    v_add_f32 v80, v64, v65
    v_add_f32 v81, v66, v67
    v_add_f32 v82, v68, v69
    v_add_f32 v83, v70, v71
    v_add_f32 v84, v72, v73
    v_add_f32 v85, v74, v75
    v_add_f32 v86, v76, v77
    v_add_f32 v87, v78, v79
    v_add_f32 v80, v80, v84
    v_add_f32 v81, v81, v85
    v_add_f32 v82, v82, v86
    v_add_f32 v83, v83, v87
    v_add_f32 v80, v80, v81
    v_add_f32 v82, v82, v83
    v_add_f32 v10, v10, v80
    v_add_f32 v10, v10, v82
    s_sub_u32 s52, s52, 1
    s_cmp_eq_u32 s52, 0
    s_cbranch_scc1 L_tail
    v_cvt_pk_bf16_f32 v52, v64, v65
    v_cvt_pk_bf16_f32 v53, v66, v67
    v_cvt_pk_bf16_f32 v54, v68, v69
    v_cvt_pk_bf16_f32 v55, v70, v71
    v_cvt_pk_bf16_f32 v56, v72, v73
    v_cvt_pk_bf16_f32 v57, v74, v75
    v_cvt_pk_bf16_f32 v58, v76, v77
    v_cvt_pk_bf16_f32 v59, v78, v79
    s_cmp_eq_u32 s84, 0
    s_cbranch_scc1 L_nopv
    v_pk_mul_f32 v[192:193], v[192:193], v[10:11] op_sel:[0,1] op_sel_hi:[1,1]
    v_pk_mul_f32 v[194:195], v[194:195], v[10:11] op_sel:[0,1] op_sel_hi:[1,1]
    v_pk_mul_f32 v[196:197], v[196:197], v[10:11] op_sel:[0,1] op_sel_hi:[1,1]
    v_pk_mul_f32 v[198:199], v[198:199], v[10:11] op_sel:[0,1] op_sel_hi:[1,1]
    v_pk_mul_f32 v[200:201], v[200:201], v[10:11] op_sel:[0,1] op_sel_hi:[1,1]
    v_pk_mul_f32 v[202:203], v[202:203], v[10:11] op_sel:[0,1] op_sel_hi:[1,1]
    v_pk_mul_f32 v[204:205], v[204:205], v[10:11] op_sel:[0,1] op_sel_hi:[1,1]
    v_pk_mul_f32 v[206:207], v[206:207], v[10:11] op_sel:[0,1] op_sel_hi:[1,1]
    v_pk_mul_f32 v[208:209], v[208:209], v[10:11] op_sel:[0,1] op_sel_hi:[1,1]
    v_pk_mul_f32 v[210:211], v[210:211], v[10:11] op_sel:[0,1] op_sel_hi:[1,1]
    v_pk_mul_f32 v[212:213], v[212:213], v[10:11] op_sel:[0,1] op_sel_hi:[1,1]
    v_pk_mul_f32 v[214:215], v[214:215], v[10:11] op_sel:[0,1] op_sel_hi:[1,1]
    v_pk_mul_f32 v[216:217], v[216:217], v[10:11] op_sel:[0,1] op_sel_hi:[1,1]
    v_pk_mul_f32 v[218:219], v[218:219], v[10:11] op_sel:[0,1] op_sel_hi:[1,1]
    v_pk_mul_f32 v[220:221], v[220:221], v[10:11] op_sel:[0,1] op_sel_hi:[1,1]
    v_pk_mul_f32 v[222:223], v[222:223], v[10:11] op_sel:[0,1] op_sel_hi:[1,1]
    v_pk_mul_f32 v[224:225], v[224:225], v[10:11] op_sel:[0,1] op_sel_hi:[1,1]
    v_pk_mul_f32 v[226:227], v[226:227], v[10:11] op_sel:[0,1] op_sel_hi:[1,1]
    v_pk_mul_f32 v[228:229], v[228:229], v[10:11] op_sel:[0,1] op_sel_hi:[1,1]
    v_pk_mul_f32 v[230:231], v[230:231], v[10:11] op_sel:[0,1] op_sel_hi:[1,1]
    v_pk_mul_f32 v[232:233], v[232:233], v[10:11] op_sel:[0,1] op_sel_hi:[1,1]
    v_pk_mul_f32 v[234:235], v[234:235], v[10:11] op_sel:[0,1] op_sel_hi:[1,1]
    v_pk_mul_f32 v[236:237], v[236:237], v[10:11] op_sel:[0,1] op_sel_hi:[1,1]
    v_pk_mul_f32 v[238:239], v[238:239], v[10:11] op_sel:[0,1] op_sel_hi:[1,1]
    v_pk_mul_f32 v[240:241], v[240:241], v[10:11] op_sel:[0,1] op_sel_hi:[1,1]
    v_pk_mul_f32 v[242:243], v[242:243], v[10:11] op_sel:[0,1] op_sel_hi:[1,1]
    v_pk_mul_f32 v[244:245], v[244:245], v[10:11] op_sel:[0,1] op_sel_hi:[1,1]
    v_pk_mul_f32 v[246:247], v[246:247], v[10:11] op_sel:[0,1] op_sel_hi:[1,1]
    v_pk_mul_f32 v[248:249], v[248:249], v[10:11] op_sel:[0,1] op_sel_hi:[1,1]
    v_pk_mul_f32 v[250:251], v[250:251], v[10:11] op_sel:[0,1] op_sel_hi:[1,1]
    v_pk_mul_f32 v[252:253], v[252:253], v[10:11] op_sel:[0,1] op_sel_hi:[1,1]
    v_pk_mul_f32 v[254:255], v[254:255], v[10:11] op_sel:[0,1] op_sel_hi:[1,1]
    s_add_u32 s56, s56, 1
    s_cmp_ge_u32 s83, s56
    s_cbranch_scc1 L_wd2
L_w2:
    ds_read_b32 v4, v3 offset:0
    s_add_u32 s82, s82, 1
    s_waitcnt lgkmcnt(0)
    v_readfirstlane_b32 s83, v4
    s_cmp_ge_u32 s83, s56
    s_cbranch_scc1 L_wd2
    s_cmp_lt_u32 s82, 0x200000
    s_cbranch_scc1 L_w2
L_wd2:
    ds_read_b64_tr_b16 v[132:133], v41 offset:0
    ds_read_b64_tr_b16 v[134:135], v41 offset:2048
    ds_read_b64_tr_b16 v[148:149], v41 offset:4096
    ds_read_b64_tr_b16 v[150:151], v41 offset:6144
    ds_read_b64_tr_b16 v[136:137], v42 offset:0
    ds_read_b64_tr_b16 v[138:139], v42 offset:2048
    ds_read_b64_tr_b16 v[152:153], v42 offset:4096
    ds_read_b64_tr_b16 v[154:155], v42 offset:6144
    ds_read_b64_tr_b16 v[140:141], v43 offset:0
    ds_read_b64_tr_b16 v[142:143], v43 offset:2048
    ds_read_b64_tr_b16 v[156:157], v43 offset:4096
    ds_read_b64_tr_b16 v[158:159], v43 offset:6144
    ds_read_b64_tr_b16 v[128:129], v40 offset:0
    ds_read_b64_tr_b16 v[130:131], v40 offset:2048
    ds_read_b64_tr_b16 v[144:145], v40 offset:4096
    ds_read_b64_tr_b16 v[146:147], v40 offset:6144
    s_waitcnt lgkmcnt(14)
    v_mfma_f32_32x32x16_bf16 v[208:223], v[132:135], v[44:47], v[208:223]
    s_waitcnt lgkmcnt(12)
    v_mfma_f32_32x32x16_bf16 v[208:223], v[148:151], v[48:51], v[208:223]
    s_waitcnt lgkmcnt(10)
    v_mfma_f32_32x32x16_bf16 v[224:239], v[136:139], v[44:47], v[224:239]
    s_waitcnt lgkmcnt(8)
    v_mfma_f32_32x32x16_bf16 v[224:239], v[152:155], v[48:51], v[224:239]
    s_waitcnt lgkmcnt(6)
    v_mfma_f32_32x32x16_bf16 v[240:255], v[140:143], v[44:47], v[240:255]
    s_waitcnt lgkmcnt(4)
    v_mfma_f32_32x32x16_bf16 v[240:255], v[156:159], v[48:51], v[240:255]
    s_waitcnt lgkmcnt(2)
    v_mfma_f32_32x32x16_bf16 v[192:207], v[128:131], v[44:47], v[192:207]
    s_waitcnt lgkmcnt(0)
    v_mfma_f32_32x32x16_bf16 v[192:207], v[144:147], v[48:51], v[192:207]
    s_mov_b64 exec, 1
    ds_add_u32 v3, v6 offset:16
    s_mov_b64 exec, -1
    v_xor_b32 v40, s71, v40
    v_xor_b32 v41, s71, v41
    v_xor_b32 v42, s71, v42
    v_xor_b32 v43, s71, v43
L_nopv:
    v_mov_b32 v44, v52
    v_mov_b32 v45, v53
    v_mov_b32 v46, v54
    v_mov_b32 v47, v55
    v_mov_b32 v48, v56
    v_mov_b32 v49, v57
    v_mov_b32 v50, v58
    v_mov_b32 v51, v59
    v_mov_b32 v11, v5
    s_mov_b32 s84, 1
    s_add_u32 s56, s56, 1
    s_cmp_ge_u32 s83, s56
    s_cbranch_scc1 L_wd3
L_w3:
    ds_read_b32 v4, v3 offset:0
    s_add_u32 s82, s82, 1
    s_waitcnt lgkmcnt(0)
    v_readfirstlane_b32 s83, v4
    s_cmp_ge_u32 s83, s56
    s_cbranch_scc1 L_wd3
    s_cmp_lt_u32 s82, 0x200000
    s_cbranch_scc1 L_w3
L_wd3:
    s_branch L_loop
L_tail:
    v_mov_b32 v12, v10
    v_mov_b32 v16, v8
    v_mov_b32 v8, v23
    v_permlane32_swap_b32 v12, v10
    v_mov_b32 v11, 1
    v_add_f32 v10, v10, v12
    ds_write_b128 v22, v[8:11]
L_ml:
    ds_read_b128 v[52:55], v163
    ds_read_b128 v[56:59], v164
    ds_read_b128 v[172:175], v165
    s_add_u32 s82, s82, 1
    s_cmp_gt_u32 s82, 0x200000
    s_cselect_b64 s[26:27], 0, -1
    s_waitcnt lgkmcnt(0)
    v_min3_u32 v12, v55, v59, v175
    v_cmp_eq_u32 vcc, 0, v12
    s_and_b64 vcc, vcc, s[26:27]
    s_cbranch_scc1 L_ml
    ds_read_b128 v[96:99], v160 offset:0
    ds_read_b128 v[100:103], v160 offset:1024
    ds_read_b128 v[104:107], v160 offset:2048
    ds_read_b128 v[108:111], v160 offset:3072
    ds_read_b128 v[112:115], v161 offset:0
    ds_read_b128 v[116:119], v161 offset:1024
    ds_read_b128 v[120:123], v161 offset:2048
    ds_read_b128 v[124:127], v161 offset:3072
    v_max3_f32 v12, v9, v53, v57
    v_max_f32 v12, v12, v173
    v_mul_f32 v12, s57, v12
    v_fma_f32 v44, v9, s57, -v12
    v_fma_f32 v45, v53, s57, -v12
    v_fma_f32 v46, v57, s57, -v12
    v_fma_f32 v47, v173, s57, -v12
    v_fma_f32 v16, v16, s57, -v12
    v_exp_f32 v44, v44
    v_exp_f32 v45, v45
    v_exp_f32 v46, v46
    v_exp_f32 v47, v47
    v_exp_f32 v16, v16
    v_mul_f32 v14, v44, v10
    v_fmac_f32 v14, v45, v54
    v_fmac_f32 v14, v46, v58
    v_fmac_f32 v14, v47, v174
    v_mul_f32 v14, s78, v14
    v_max_f32 v14, 0x0da24260, v14
    v_rcp_f32 v15, v14
    v_log_f32 v24, v14
    v_mul_f32 v16, v16, v15
    v_mul_f32 v13, v44, v15
    v_pk_mul_f32 v[176:177], v[176:177], v[16:17] op_sel:[0,0] op_sel_hi:[1,0]
    v_pk_mul_f32 v[178:179], v[178:179], v[16:17] op_sel:[0,0] op_sel_hi:[1,0]
    v_pk_mul_f32 v[180:181], v[180:181], v[16:17] op_sel:[0,0] op_sel_hi:[1,0]
    v_pk_mul_f32 v[182:183], v[182:183], v[16:17] op_sel:[0,0] op_sel_hi:[1,0]
    v_pk_mul_f32 v[184:185], v[184:185], v[16:17] op_sel:[0,0] op_sel_hi:[1,0]
    v_pk_mul_f32 v[186:187], v[186:187], v[16:17] op_sel:[0,0] op_sel_hi:[1,0]
    v_pk_mul_f32 v[188:189], v[188:189], v[16:17] op_sel:[0,0] op_sel_hi:[1,0]
    v_pk_mul_f32 v[190:191], v[190:191], v[16:17] op_sel:[0,0] op_sel_hi:[1,0]
    v_cvt_pk_bf16_f32 v80, v176, v177
    v_cvt_pk_bf16_f32 v81, v178, v179
    v_cvt_pk_bf16_f32 v82, v180, v181
    v_cvt_pk_bf16_f32 v83, v182, v183
    v_cvt_pk_bf16_f32 v84, v184, v185
    v_cvt_pk_bf16_f32 v85, v186, v187
    v_cvt_pk_bf16_f32 v86, v188, v189
    v_cvt_pk_bf16_f32 v87, v190, v191
    ds_read_b128 v[176:179], v162 offset:0
    ds_read_b128 v[180:183], v162 offset:1024
    ds_read_b128 v[184:187], v162 offset:2048
    ds_read_b128 v[188:191], v162 offset:3072
    ds_write_b128 v166, v[80:83] offset:12288
    ds_write_b128 v166, v[84:87] offset:13312
    v_pk_mul_f32 v[64:65], v[64:65], v[12:13] op_sel:[0,1] op_sel_hi:[1,1]
    v_pk_mul_f32 v[66:67], v[66:67], v[12:13] op_sel:[0,1] op_sel_hi:[1,1]
    v_pk_mul_f32 v[68:69], v[68:69], v[12:13] op_sel:[0,1] op_sel_hi:[1,1]
    v_pk_mul_f32 v[70:71], v[70:71], v[12:13] op_sel:[0,1] op_sel_hi:[1,1]
    v_pk_mul_f32 v[72:73], v[72:73], v[12:13] op_sel:[0,1] op_sel_hi:[1,1]
    v_pk_mul_f32 v[74:75], v[74:75], v[12:13] op_sel:[0,1] op_sel_hi:[1,1]
    v_pk_mul_f32 v[76:77], v[76:77], v[12:13] op_sel:[0,1] op_sel_hi:[1,1]
    v_pk_mul_f32 v[78:79], v[78:79], v[12:13] op_sel:[0,1] op_sel_hi:[1,1]
    v_cvt_pk_bf16_f32 v88, v64, v65
    v_cvt_pk_bf16_f32 v89, v66, v67
    v_cvt_pk_bf16_f32 v90, v68, v69
    v_cvt_pk_bf16_f32 v91, v70, v71
    v_cvt_pk_bf16_f32 v92, v72, v73
    v_cvt_pk_bf16_f32 v93, v74, v75
    v_cvt_pk_bf16_f32 v94, v76, v77
    v_cvt_pk_bf16_f32 v95, v78, v79
    ds_write_b128 v166, v[88:91] offset:14336
    ds_write_b128 v166, v[92:95] offset:15360
    s_mov_b64 exec, 1
    ds_add_u32 v169, v6 offset:56
    s_mov_b64 exec, -1
    v_fma_f32 v25, v8, s57, -v12
    v_fma_f32 v26, v52, s57, -v12
    v_fma_f32 v27, v56, s57, -v12
    v_fma_f32 v28, v172, s57, -v12
    v_exp_f32 v25, v25
    v_exp_f32 v26, v26
    v_exp_f32 v27, v27
    v_exp_f32 v28, v28
    v_add_f32 v24, v24, v12
    v_add_u32 v12, -1, v19
    v_mul_f32 v25, v25, v15
    v_mul_f32 v26, v26, v15
    v_mul_f32 v27, v27, v15
    v_mul_f32 v28, v28, v15
L_w4:
    ds_read_b32 v4, v17
    s_add_u32 s82, s82, 1
    s_waitcnt lgkmcnt(0)
    v_cmp_lt_u32 s[26:27], v4, v12
    s_cmp_gt_u32 s82, 0x200000
    s_cbranch_scc1 L_wd4
    s_cmp_lg_u32 s26, 0
    s_cbranch_scc1 L_w4
L_wd4:
    ds_read_b128 v[208:211], v170 offset:12288
    ds_read_b128 v[212:215], v170 offset:13312
    ds_read_b64_tr_b16 v[128:129], v60 offset:0
    ds_read_b64_tr_b16 v[130:131], v60 offset:2048
    ds_read_b64_tr_b16 v[132:133], v60 offset:4096
    ds_read_b64_tr_b16 v[134:135], v60 offset:6144
    v_xor_b32 v60, s71, v60
    ds_read_b128 v[216:219], v171 offset:12288
    ds_read_b128 v[220:223], v171 offset:13312
    ds_read_b64_tr_b16 v[136:137], v61 offset:0
    ds_read_b64_tr_b16 v[138:139], v61 offset:2048
    ds_read_b64_tr_b16 v[140:141], v61 offset:4096
    ds_read_b64_tr_b16 v[142:143], v61 offset:6144
    v_xor_b32 v61, s71, v61
    ds_read_b128 v[224:227], v20 offset:12288
    ds_read_b128 v[228:231], v20 offset:13312
    ds_read_b64_tr_b16 v[144:145], v62 offset:0
    ds_read_b64_tr_b16 v[146:147], v62 offset:2048
    ds_read_b64_tr_b16 v[148:149], v62 offset:4096
    ds_read_b64_tr_b16 v[150:151], v62 offset:6144
    v_xor_b32 v62, s71, v62
    ds_read_b128 v[232:235], v21 offset:12288
    ds_read_b128 v[236:239], v21 offset:13312
    ds_read_b64_tr_b16 v[152:153], v63 offset:0
    ds_read_b64_tr_b16 v[154:155], v63 offset:2048
    ds_read_b64_tr_b16 v[156:157], v63 offset:4096
    ds_read_b64_tr_b16 v[158:159], v63 offset:6144
    v_xor_b32 v63, s71, v63
    s_cmp_lg_u32 s67, 0
    s_cbranch_scc1 L_mix
    v_pk_mul_f32 v[192:193], v[192:193], v[24:25] op_sel:[0,1] op_sel_hi:[1,1]
    v_pk_mul_f32 v[194:195], v[194:195], v[24:25] op_sel:[0,1] op_sel_hi:[1,1]
    v_pk_mul_f32 v[196:197], v[196:197], v[24:25] op_sel:[0,1] op_sel_hi:[1,1]
    v_pk_mul_f32 v[198:199], v[198:199], v[24:25] op_sel:[0,1] op_sel_hi:[1,1]
    v_pk_mul_f32 v[200:201], v[200:201], v[24:25] op_sel:[0,1] op_sel_hi:[1,1]
    v_pk_mul_f32 v[202:203], v[202:203], v[24:25] op_sel:[0,1] op_sel_hi:[1,1]
    v_pk_mul_f32 v[204:205], v[204:205], v[24:25] op_sel:[0,1] op_sel_hi:[1,1]
    v_pk_mul_f32 v[206:207], v[206:207], v[24:25] op_sel:[0,1] op_sel_hi:[1,1]
    s_waitcnt lgkmcnt(15)
    v_mfma_f32_32x32x16_bf16 v[80:95], v[128:131], v[208:211], 0
    v_pk_fma_f32 v[192:193], v[96:97], v[26:27], v[192:193] op_sel:[0,0,0] op_sel_hi:[1,0,1]
    v_pk_fma_f32 v[194:195], v[98:99], v[26:27], v[194:195] op_sel:[0,0,0] op_sel_hi:[1,0,1]
    v_pk_fma_f32 v[196:197], v[100:101], v[26:27], v[196:197] op_sel:[0,0,0] op_sel_hi:[1,0,1]
    v_lshl_add_u32 v14, v1, 2, s58
    v_and_b32 v13, 7, v1
    v_mfma_f32_32x32x16_bf16 v[80:95], v[132:135], v[212:215], v[80:95]
    v_pk_fma_f32 v[198:199], v[102:103], v[26:27], v[198:199] op_sel:[0,0,0] op_sel_hi:[1,0,1]
    v_pk_fma_f32 v[200:201], v[104:105], v[26:27], v[200:201] op_sel:[0,0,0] op_sel_hi:[1,0,1]
    v_pk_fma_f32 v[202:203], v[106:107], v[26:27], v[202:203] op_sel:[0,0,0] op_sel_hi:[1,0,1]
    v_lshl_add_u32 v50, v13, 2, s9
    v_lshl_add_u32 v51, v13, 2, s58
    s_waitcnt lgkmcnt(12)
    v_mfma_f32_32x32x16_bf16 v[80:95], v[136:139], v[216:219], v[80:95]
    v_pk_fma_f32 v[204:205], v[108:109], v[26:27], v[204:205] op_sel:[0,0,0] op_sel_hi:[1,0,1]
    v_pk_fma_f32 v[206:207], v[110:111], v[26:27], v[206:207] op_sel:[0,0,0] op_sel_hi:[1,0,1]
    v_pk_fma_f32 v[192:193], v[112:113], v[26:27], v[192:193] op_sel:[0,1,0] op_sel_hi:[1,1,1]
    v_lshlrev_b32 v12, 4, v13
    v_lshrrev_b32 v13, 5, v1
    v_mfma_f32_32x32x16_bf16 v[80:95], v[140:143], v[220:223], v[80:95]
    v_pk_fma_f32 v[194:195], v[114:115], v[26:27], v[194:195] op_sel:[0,1,0] op_sel_hi:[1,1,1]
    v_pk_fma_f32 v[196:197], v[116:117], v[26:27], v[196:197] op_sel:[0,1,0] op_sel_hi:[1,1,1]
    v_pk_fma_f32 v[198:199], v[118:119], v[26:27], v[198:199] op_sel:[0,1,0] op_sel_hi:[1,1,1]
    v_lshl_add_u32 v12, v13, 10, v12
    v_bfe_u32 v13, v1, 3, 1
    s_waitcnt lgkmcnt(6)
    v_mfma_f32_32x32x16_bf16 v[80:95], v[144:147], v[224:227], v[80:95]
    v_pk_fma_f32 v[200:201], v[120:121], v[26:27], v[200:201] op_sel:[0,1,0] op_sel_hi:[1,1,1]
    v_pk_fma_f32 v[202:203], v[122:123], v[26:27], v[202:203] op_sel:[0,1,0] op_sel_hi:[1,1,1]
    v_pk_fma_f32 v[204:205], v[124:125], v[26:27], v[204:205] op_sel:[0,1,0] op_sel_hi:[1,1,1]
    v_lshl_add_u32 v12, v13, 9, v12
    v_bfe_u32 v13, v1, 4, 1
    v_mfma_f32_32x32x16_bf16 v[80:95], v[148:151], v[228:231], v[80:95]
    v_pk_fma_f32 v[206:207], v[126:127], v[26:27], v[206:207] op_sel:[0,1,0] op_sel_hi:[1,1,1]
    v_pk_fma_f32 v[192:193], v[176:177], v[28:29], v[192:193] op_sel:[0,0,0] op_sel_hi:[1,0,1]
    v_pk_fma_f32 v[194:195], v[178:179], v[28:29], v[194:195] op_sel:[0,0,0] op_sel_hi:[1,0,1]
    v_lshl_add_u32 v12, v13, 3, v12
    v_add_u32 v22, s25, v12
    s_waitcnt lgkmcnt(0)
    v_mfma_f32_32x32x16_bf16 v[80:95], v[152:155], v[232:235], v[80:95]
    v_pk_fma_f32 v[196:197], v[180:181], v[28:29], v[196:197] op_sel:[0,0,0] op_sel_hi:[1,0,1]
    v_pk_fma_f32 v[198:199], v[182:183], v[28:29], v[198:199] op_sel:[0,0,0] op_sel_hi:[1,0,1]
    v_pk_fma_f32 v[200:201], v[184:185], v[28:29], v[200:201] op_sel:[0,0,0] op_sel_hi:[1,0,1]
    v_add_u32 v23, s8, v12
    v_and_b32 v13, 15, v1
    v_mfma_f32_32x32x16_bf16 v[80:95], v[156:159], v[236:239], v[80:95]
    v_pk_fma_f32 v[202:203], v[186:187], v[28:29], v[202:203] op_sel:[0,0,0] op_sel_hi:[1,0,1]
    v_pk_fma_f32 v[204:205], v[188:189], v[28:29], v[204:205] op_sel:[0,0,0] op_sel_hi:[1,0,1]
    v_pk_fma_f32 v[206:207], v[190:191], v[28:29], v[206:207] op_sel:[0,0,0] op_sel_hi:[1,0,1]
    v_lshlrev_b32 v13, 3, v13
    v_sub_u32 v2, v167, v13
    ds_write_b32 v14, v24 offset:8192
    ds_read_b32 v50, v50 offset:8192
    ds_read_b32 v51, v51 offset:8288
    ds_read_b128 v[96:99], v170 offset:14336
    ds_read_b128 v[100:103], v170 offset:15360
    ds_read_b128 v[104:107], v171 offset:14336
    ds_read_b128 v[108:111], v171 offset:15360
    ds_read_b128 v[112:115], v20 offset:14336
    ds_read_b128 v[116:119], v20 offset:15360
    ds_read_b128 v[120:123], v21 offset:14336
    ds_read_b128 v[124:127], v21 offset:15360
    v_mov_b32 v72, v24
    v_add_u32 v73, v24, v30
    v_cndmask_b32 v5, 0, v30, s[12:13]
    s_bitcmp1_b32 s77, 1
    s_cselect_b64 vcc, -1, 0
    s_waitcnt vmcnt(0)
    v_xor_b32 v48, s68, v48
    v_xor_b32 v49, s46, v49
    v_or_b32 v48, v48, v49
    v_cmp_ne_u32 s[86:87], 0, v48
    s_bitcmp0_b32 s77, 0
    s_cbranch_scc1 L_pre0
    buffer_load_dwordx4 v[208:211], v167, s[36:39], s73 offen sc1
    buffer_load_dwordx4 v[212:215], v167, s[36:39], s73 offen offset:256 sc1
    buffer_load_dwordx2 v[216:217], v2, s[36:39], s73 offen offset:512 sc1
    s_cbranch_vccz L_pre0
    buffer_load_dwordx4 v[224:227], v167, s[36:39], s74 offen sc1
    buffer_load_dwordx4 v[228:231], v167, s[36:39], s74 offen offset:256 sc1
    buffer_load_dwordx2 v[232:233], v2, s[36:39], s74 offen offset:512 sc1
L_pre0:
    v_pk_add_f32 v[192:193], v[192:193], v[80:81]
    v_pk_add_f32 v[194:195], v[194:195], v[82:83]
    v_pk_add_f32 v[196:197], v[196:197], v[84:85]
    v_pk_add_f32 v[198:199], v[198:199], v[86:87]
    v_pk_add_f32 v[200:201], v[200:201], v[88:89]
    v_pk_add_f32 v[202:203], v[202:203], v[90:91]
    v_pk_add_f32 v[204:205], v[204:205], v[92:93]
    v_pk_add_f32 v[206:207], v[206:207], v[94:95]
    s_mov_b32 s26, -1
    s_bitcmp0_b32 s26, 0
    s_cbranch_scc1 L_wd5
L_w5:
    ds_read_b32 v4, v17
    s_add_u32 s82, s82, 1
    s_waitcnt lgkmcnt(0)
    v_cmp_lt_u32 s[26:27], v4, v19
    s_cmp_gt_u32 s82, 0x200000
    s_cbranch_scc1 L_wd5
    s_bitcmp1_b32 s26, 0
    s_cbranch_scc1 L_w5
L_wd5:
    ds_read_b64_tr_b16 v[128:129], v60 offset:0
    ds_read_b64_tr_b16 v[130:131], v60 offset:2048
    ds_read_b64_tr_b16 v[132:133], v60 offset:4096
    ds_read_b64_tr_b16 v[134:135], v60 offset:6144
    s_bitcmp0_b32 s26, 1
    s_cbranch_scc1 L_wd6
L_w6:
    ds_read_b32 v4, v17
    s_add_u32 s82, s82, 1
    s_waitcnt lgkmcnt(0)
    v_cmp_lt_u32 s[26:27], v4, v19
    s_cmp_gt_u32 s82, 0x200000
    s_cbranch_scc1 L_wd6
    s_bitcmp1_b32 s26, 1
    s_cbranch_scc1 L_w6
L_wd6:
    ds_read_b64_tr_b16 v[136:137], v61 offset:0
    ds_read_b64_tr_b16 v[138:139], v61 offset:2048
    ds_read_b64_tr_b16 v[140:141], v61 offset:4096
    ds_read_b64_tr_b16 v[142:143], v61 offset:6144
    s_waitcnt lgkmcnt(4)
    v_mfma_f32_32x32x16_bf16 v[192:207], v[128:131], v[96:99], v[192:207]
    v_mfma_f32_32x32x16_bf16 v[192:207], v[132:135], v[100:103], v[192:207]
    s_waitcnt lgkmcnt(0)
    v_mfma_f32_32x32x16_bf16 v[192:207], v[136:139], v[104:107], v[192:207]
    v_mfma_f32_32x32x16_bf16 v[192:207], v[140:143], v[108:111], v[192:207]
    s_barrier
    ds_read_b64_tr_b16 v[144:145], v62 offset:0
    ds_read_b64_tr_b16 v[146:147], v62 offset:2048
    ds_read_b64_tr_b16 v[152:153], v63 offset:0
    ds_read_b64_tr_b16 v[154:155], v63 offset:2048
    s_waitcnt lgkmcnt(2)
    v_mfma_f32_32x32x16_bf16 v[192:207], v[144:147], v[112:115], v[192:207]
    s_waitcnt lgkmcnt(0)
    v_mfma_f32_32x32x16_bf16 v[192:207], v[152:155], v[120:123], v[192:207]
    s_barrier
    ds_read_b64_tr_b16 v[148:149], v62 offset:4096
    ds_read_b64_tr_b16 v[150:151], v62 offset:6144
    ds_read_b64_tr_b16 v[156:157], v63 offset:4096
    ds_read_b64_tr_b16 v[158:159], v63 offset:6144
    s_waitcnt lgkmcnt(2)
    v_mfma_f32_32x32x16_bf16 v[192:207], v[148:151], v[116:119], v[192:207]
    s_waitcnt lgkmcnt(0)
    v_mfma_f32_32x32x16_bf16 v[192:207], v[156:159], v[124:127], v[192:207]
L_pub:
    s_cmp_lg_u64 s[86:87], 0
    s_cbranch_scc1 L_far0
    s_nop 9
    v_cvt_pk_bf16_f32 v64, v192, v193
    v_cvt_pk_bf16_f32 v65, v194, v195
    v_cvt_pk_bf16_f32 v66, v196, v197
    v_cvt_pk_bf16_f32 v67, v198, v199
    v_cvt_pk_bf16_f32 v68, v200, v201
    v_cvt_pk_bf16_f32 v69, v202, v203
    v_cvt_pk_bf16_f32 v70, v204, v205
    v_cvt_pk_bf16_f32 v71, v206, v207
    s_mov_b64 exec, s[10:11]
    buffer_store_dwordx4 v[64:67], v0, s[36:39], s59 offen
    v_add3_u32 v73, v73, v64, v65
    v_add3_u32 v74, v66, v67, v68
    buffer_store_dwordx4 v[68:71], v0, s[36:39], s59 offen offset:256
    v_add3_u32 v73, v73, v69, v70
    v_add3_u32 v73, v73, v71, v74
    buffer_store_dwordx2 v[72:73], v7, s[36:39], s59 offen offset:512
    s_mov_b64 exec, -1
L_sent0:
    ds_write_b128 v166, v[64:67] offset:0
    ds_write_b128 v166, v[68:71] offset:1024
    s_mov_b32 s82, 0
    s_bitcmp0_b32 s77, 0
    s_cbranch_scc1 L_fin
    ds_read_b64 v[218:219], v22
    ds_read_b64 v[234:235], v23
    v_mov_b32 v16, 0xff61b1e6
    s_branch L_j2a
L_poll:
    buffer_load_dwordx4 v[208:211], v167, s[36:39], s73 offen sc1
    buffer_load_dwordx4 v[212:215], v167, s[36:39], s73 offen offset:256 sc1
    buffer_load_dwordx2 v[216:217], v2, s[36:39], s73 offen offset:512 sc1
    s_cbranch_vccz L_j2a
    buffer_load_dwordx4 v[224:227], v167, s[36:39], s74 offen sc1
    buffer_load_dwordx4 v[228:231], v167, s[36:39], s74 offen offset:256 sc1
    buffer_load_dwordx2 v[232:233], v2, s[36:39], s74 offen offset:512 sc1
L_j2a:
    s_add_u32 s82, s82, 1
    s_cmp_gt_u32 s82, 0x40000
    s_cselect_b64 s[26:27], 0, -1
    s_waitcnt vmcnt(0) lgkmcnt(0)
    v_add3_u32 v80, v208, v209, v210
    v_add3_u32 v81, v211, v212, v213
    v_add3_u32 v82, v214, v215, v216
    v_xor_b32_dpp v83, v216, v216 row_ror:8 row_mask:0xf bank_mask:0xf
    v_add3_u32 v80, v80, v81, v82
    v_sub_u32 v81, v217, v5
    v_xor_b32 v80, v80, v81
    v_or_b32 v13, v80, v83
    s_cbranch_vccz L_j2b
    v_add3_u32 v80, v224, v225, v226
    v_add3_u32 v81, v227, v228, v229
    v_add3_u32 v82, v230, v231, v232
    v_xor_b32_dpp v83, v232, v232 row_ror:8 row_mask:0xf bank_mask:0xf
    v_add3_u32 v80, v80, v81, v82
    v_sub_u32 v81, v233, v5
    v_xor_b32 v80, v80, v81
    v_or3_b32 v13, v13, v80, v83
L_j2b:
    v_cmp_ne_u32 s[86:87], 0, v13
    s_and_b64 s[86:87], s[86:87], s[26:27]
    s_cbranch_scc1 L_poll
L_got:
    v_cndmask_b32 v216, v16, v216, s[12:13]
    v_max_f32 v12, v216, v50
    v_max_f32 v13, v216, v50
    v_lshlrev_b32 v80, 16, v208
    v_and_b32 v81, 0xffff0000, v208
    v_permlane32_swap_b32 v12, v13
    v_max_f32 v14, v12, v13
    v_max_f32 v13, v12, v13
    v_lshlrev_b32 v82, 16, v209
    v_and_b32 v83, 0xffff0000, v209
    v_permlane16_swap_b32 v14, v13
    v_max_f32 v12, v14, v13
    v_sub_f32 v216, v216, v12
    v_sub_f32 v50, v50, v12
    v_exp_f32 v216, v216
    v_exp_f32 v50, v50
    v_lshlrev_b32 v84, 16, v210
    v_and_b32 v85, 0xffff0000, v210
    v_lshlrev_b32 v86, 16, v211
    v_and_b32 v87, 0xffff0000, v211
    v_lshlrev_b32 v88, 16, v212
    v_and_b32 v89, 0xffff0000, v212
    v_lshlrev_b32 v90, 16, v213
    v_and_b32 v91, 0xffff0000, v213
    v_lshlrev_b32 v92, 16, v214
    v_and_b32 v93, 0xffff0000, v214
    v_lshlrev_b32 v94, 16, v215
    v_and_b32 v95, 0xffff0000, v215
    v_mov_b32 v12, v216
    v_mov_b32 v13, v216
    v_pk_mul_f32 v[80:81], v[80:81], v[216:217] op_sel:[0,0] op_sel_hi:[1,0]
    v_pk_mul_f32 v[82:83], v[82:83], v[216:217] op_sel:[0,0] op_sel_hi:[1,0]
    v_pk_mul_f32 v[84:85], v[84:85], v[216:217] op_sel:[0,0] op_sel_hi:[1,0]
    v_pk_mul_f32 v[86:87], v[86:87], v[216:217] op_sel:[0,0] op_sel_hi:[1,0]
    v_pk_mul_f32 v[88:89], v[88:89], v[216:217] op_sel:[0,0] op_sel_hi:[1,0]
    v_pk_mul_f32 v[90:91], v[90:91], v[216:217] op_sel:[0,0] op_sel_hi:[1,0]
    v_pk_mul_f32 v[92:93], v[92:93], v[216:217] op_sel:[0,0] op_sel_hi:[1,0]
    v_pk_mul_f32 v[94:95], v[94:95], v[216:217] op_sel:[0,0] op_sel_hi:[1,0]
    v_permlane32_swap_b32 v12, v13
    v_permlane32_swap_b32 v80, v88
    v_permlane32_swap_b32 v81, v89
    v_permlane32_swap_b32 v82, v90
    v_permlane32_swap_b32 v83, v91
    v_permlane32_swap_b32 v84, v92
    v_permlane32_swap_b32 v85, v93
    v_permlane32_swap_b32 v86, v94
    v_permlane32_swap_b32 v87, v95
    v_add_f32 v14, v12, v13
    v_add_f32 v13, v12, v13
    v_pk_add_f32 v[80:81], v[80:81], v[88:89]
    v_pk_add_f32 v[82:83], v[82:83], v[90:91]
    v_pk_add_f32 v[84:85], v[84:85], v[92:93]
    v_pk_add_f32 v[86:87], v[86:87], v[94:95]
    v_lshlrev_b32 v88, 16, v218
    v_and_b32 v89, 0xffff0000, v218
    v_permlane16_swap_b32 v14, v13
    v_permlane16_swap_b32 v80, v84
    v_permlane16_swap_b32 v81, v85
    v_permlane16_swap_b32 v82, v86
    v_permlane16_swap_b32 v83, v87
    v_add_f32 v12, v14, v13
    v_add_f32 v12, v12, v50
    v_rcp_f32 v12, v12
    v_lshlrev_b32 v90, 16, v219
    v_and_b32 v91, 0xffff0000, v219
    v_pk_add_f32 v[80:81], v[80:81], v[84:85]
    v_pk_add_f32 v[82:83], v[82:83], v[86:87]
    v_pk_fma_f32 v[80:81], v[88:89], v[50:51], v[80:81] op_sel:[0,0,0] op_sel_hi:[1,0,1]
    v_pk_fma_f32 v[82:83], v[90:91], v[50:51], v[82:83] op_sel:[0,0,0] op_sel_hi:[1,0,1]
    v_pk_mul_f32 v[80:81], v[80:81], v[12:13] op_sel:[0,0] op_sel_hi:[1,0]
    v_pk_mul_f32 v[82:83], v[82:83], v[12:13] op_sel:[0,0] op_sel_hi:[1,0]
    v_cvt_pk_bf16_f32 v94, v80, v81
    v_cvt_pk_bf16_f32 v95, v82, v83
    buffer_store_dwordx2 v[94:95], v168, s[40:43], s75 offen
    s_cbranch_vccz L_merged
    v_cndmask_b32 v232, v16, v232, s[12:13]
    v_max_f32 v112, v232, v51
    v_max_f32 v113, v232, v51
    v_lshlrev_b32 v96, 16, v224
    v_and_b32 v97, 0xffff0000, v224
    v_permlane32_swap_b32 v112, v113
    v_max_f32 v114, v112, v113
    v_max_f32 v113, v112, v113
    v_lshlrev_b32 v98, 16, v225
    v_and_b32 v99, 0xffff0000, v225
    v_permlane16_swap_b32 v114, v113
    v_max_f32 v112, v114, v113
    v_sub_f32 v232, v232, v112
    v_sub_f32 v51, v51, v112
    v_exp_f32 v232, v232
    v_exp_f32 v51, v51
    v_lshlrev_b32 v100, 16, v226
    v_and_b32 v101, 0xffff0000, v226
    v_lshlrev_b32 v102, 16, v227
    v_and_b32 v103, 0xffff0000, v227
    v_lshlrev_b32 v104, 16, v228
    v_and_b32 v105, 0xffff0000, v228
    v_lshlrev_b32 v106, 16, v229
    v_and_b32 v107, 0xffff0000, v229
    v_lshlrev_b32 v108, 16, v230
    v_and_b32 v109, 0xffff0000, v230
    v_lshlrev_b32 v110, 16, v231
    v_and_b32 v111, 0xffff0000, v231
    v_mov_b32 v112, v232
    v_mov_b32 v113, v232
    v_pk_mul_f32 v[96:97], v[96:97], v[232:233] op_sel:[0,0] op_sel_hi:[1,0]
    v_pk_mul_f32 v[98:99], v[98:99], v[232:233] op_sel:[0,0] op_sel_hi:[1,0]
    v_pk_mul_f32 v[100:101], v[100:101], v[232:233] op_sel:[0,0] op_sel_hi:[1,0]
    v_pk_mul_f32 v[102:103], v[102:103], v[232:233] op_sel:[0,0] op_sel_hi:[1,0]
    v_pk_mul_f32 v[104:105], v[104:105], v[232:233] op_sel:[0,0] op_sel_hi:[1,0]
    v_pk_mul_f32 v[106:107], v[106:107], v[232:233] op_sel:[0,0] op_sel_hi:[1,0]
    v_pk_mul_f32 v[108:109], v[108:109], v[232:233] op_sel:[0,0] op_sel_hi:[1,0]
    v_pk_mul_f32 v[110:111], v[110:111], v[232:233] op_sel:[0,0] op_sel_hi:[1,0]
    v_permlane32_swap_b32 v112, v113
    v_permlane32_swap_b32 v96, v104
    v_permlane32_swap_b32 v97, v105
    v_permlane32_swap_b32 v98, v106
    v_permlane32_swap_b32 v99, v107
    v_permlane32_swap_b32 v100, v108
    v_permlane32_swap_b32 v101, v109
    v_permlane32_swap_b32 v102, v110
    v_permlane32_swap_b32 v103, v111
    v_add_f32 v114, v112, v113
    v_add_f32 v113, v112, v113
    v_pk_add_f32 v[96:97], v[96:97], v[104:105]
    v_pk_add_f32 v[98:99], v[98:99], v[106:107]
    v_pk_add_f32 v[100:101], v[100:101], v[108:109]
    v_pk_add_f32 v[102:103], v[102:103], v[110:111]
    v_lshlrev_b32 v104, 16, v234
    v_and_b32 v105, 0xffff0000, v234
    v_permlane16_swap_b32 v114, v113
    v_permlane16_swap_b32 v96, v100
    v_permlane16_swap_b32 v97, v101
    v_permlane16_swap_b32 v98, v102
    v_permlane16_swap_b32 v99, v103
    v_add_f32 v112, v114, v113
    v_add_f32 v112, v112, v51
    v_rcp_f32 v112, v112
    v_lshlrev_b32 v106, 16, v235
    v_and_b32 v107, 0xffff0000, v235
    v_pk_add_f32 v[96:97], v[96:97], v[100:101]
    v_pk_add_f32 v[98:99], v[98:99], v[102:103]
    v_pk_fma_f32 v[96:97], v[104:105], v[50:51], v[96:97] op_sel:[0,1,0] op_sel_hi:[1,1,1]
    v_pk_fma_f32 v[98:99], v[106:107], v[50:51], v[98:99] op_sel:[0,1,0] op_sel_hi:[1,1,1]
    v_pk_mul_f32 v[96:97], v[96:97], v[112:113] op_sel:[0,0] op_sel_hi:[1,0]
    v_pk_mul_f32 v[98:99], v[98:99], v[112:113] op_sel:[0,0] op_sel_hi:[1,0]
    v_cvt_pk_bf16_f32 v110, v96, v97
    v_cvt_pk_bf16_f32 v111, v98, v99
    buffer_store_dwordx2 v[110:111], v168, s[40:43], s76 offen
L_merged:
    s_cmp_lg_u32 s24, 0
    s_cbranch_scc1 L_fin
    v_mov_b32 v12, s72
    s_mov_b64 exec, 1
    global_store_dword v12, v30, s[18:19]
    s_mov_b64 exec, -1
L_fin:
L_end:
    s_endpgm
L_mix:
    v_pk_mul_f32 v[192:193], v[192:193], v[24:25] op_sel:[0,1] op_sel_hi:[1,1]
    v_pk_mul_f32 v[194:195], v[194:195], v[24:25] op_sel:[0,1] op_sel_hi:[1,1]
    v_pk_mul_f32 v[196:197], v[196:197], v[24:25] op_sel:[0,1] op_sel_hi:[1,1]
    v_pk_mul_f32 v[198:199], v[198:199], v[24:25] op_sel:[0,1] op_sel_hi:[1,1]
    v_pk_mul_f32 v[200:201], v[200:201], v[24:25] op_sel:[0,1] op_sel_hi:[1,1]
    v_pk_mul_f32 v[202:203], v[202:203], v[24:25] op_sel:[0,1] op_sel_hi:[1,1]
    v_pk_mul_f32 v[204:205], v[204:205], v[24:25] op_sel:[0,1] op_sel_hi:[1,1]
    v_pk_mul_f32 v[206:207], v[206:207], v[24:25] op_sel:[0,1] op_sel_hi:[1,1]
    v_pk_mul_f32 v[240:241], v[96:97], v[26:27] op_sel:[0,0] op_sel_hi:[1,0]
    v_pk_mul_f32 v[242:243], v[98:99], v[26:27] op_sel:[0,0] op_sel_hi:[1,0]
    v_pk_mul_f32 v[244:245], v[100:101], v[26:27] op_sel:[0,0] op_sel_hi:[1,0]
    v_pk_mul_f32 v[246:247], v[102:103], v[26:27] op_sel:[0,0] op_sel_hi:[1,0]
    v_pk_mul_f32 v[248:249], v[104:105], v[26:27] op_sel:[0,0] op_sel_hi:[1,0]
    v_pk_mul_f32 v[250:251], v[106:107], v[26:27] op_sel:[0,0] op_sel_hi:[1,0]
    v_pk_mul_f32 v[252:253], v[108:109], v[26:27] op_sel:[0,0] op_sel_hi:[1,0]
    v_pk_mul_f32 v[254:255], v[110:111], v[26:27] op_sel:[0,0] op_sel_hi:[1,0]
    v_pk_fma_f32 v[192:193], v[112:113], v[26:27], v[192:193] op_sel:[0,1,0] op_sel_hi:[1,1,1]
    v_pk_fma_f32 v[194:195], v[114:115], v[26:27], v[194:195] op_sel:[0,1,0] op_sel_hi:[1,1,1]
    v_pk_fma_f32 v[196:197], v[116:117], v[26:27], v[196:197] op_sel:[0,1,0] op_sel_hi:[1,1,1]
    v_pk_fma_f32 v[198:199], v[118:119], v[26:27], v[198:199] op_sel:[0,1,0] op_sel_hi:[1,1,1]
    v_pk_fma_f32 v[200:201], v[120:121], v[26:27], v[200:201] op_sel:[0,1,0] op_sel_hi:[1,1,1]
    v_pk_fma_f32 v[202:203], v[122:123], v[26:27], v[202:203] op_sel:[0,1,0] op_sel_hi:[1,1,1]
    v_pk_fma_f32 v[204:205], v[124:125], v[26:27], v[204:205] op_sel:[0,1,0] op_sel_hi:[1,1,1]
    v_pk_fma_f32 v[206:207], v[126:127], v[26:27], v[206:207] op_sel:[0,1,0] op_sel_hi:[1,1,1]
    v_pk_fma_f32 v[240:241], v[176:177], v[28:29], v[240:241] op_sel:[0,0,0] op_sel_hi:[1,0,1]
    v_pk_fma_f32 v[242:243], v[178:179], v[28:29], v[242:243] op_sel:[0,0,0] op_sel_hi:[1,0,1]
    v_pk_fma_f32 v[244:245], v[180:181], v[28:29], v[244:245] op_sel:[0,0,0] op_sel_hi:[1,0,1]
    v_pk_fma_f32 v[246:247], v[182:183], v[28:29], v[246:247] op_sel:[0,0,0] op_sel_hi:[1,0,1]
    v_pk_fma_f32 v[248:249], v[184:185], v[28:29], v[248:249] op_sel:[0,0,0] op_sel_hi:[1,0,1]
    v_pk_fma_f32 v[250:251], v[186:187], v[28:29], v[250:251] op_sel:[0,0,0] op_sel_hi:[1,0,1]
    v_pk_fma_f32 v[252:253], v[188:189], v[28:29], v[252:253] op_sel:[0,0,0] op_sel_hi:[1,0,1]
    v_pk_fma_f32 v[254:255], v[190:191], v[28:29], v[254:255] op_sel:[0,0,0] op_sel_hi:[1,0,1]
    s_waitcnt lgkmcnt(0)
    v_mfma_f32_32x32x16_bf16 v[192:207], v[128:131], v[208:211], v[192:207]
    v_lshl_add_u32 v14, v1, 2, s58
    v_and_b32 v13, 7, v1
    v_mfma_f32_32x32x16_bf16 v[192:207], v[132:135], v[212:215], v[192:207]
    v_lshl_add_u32 v50, v13, 2, s9
    v_lshl_add_u32 v51, v13, 2, s58
    v_mfma_f32_32x32x16_bf16 v[240:255], v[136:139], v[216:219], v[240:255]
    v_lshlrev_b32 v12, 4, v13
    v_lshrrev_b32 v13, 5, v1
    v_mfma_f32_32x32x16_bf16 v[240:255], v[140:143], v[220:223], v[240:255]
    v_lshl_add_u32 v12, v13, 10, v12
    v_bfe_u32 v13, v1, 3, 1
    v_mfma_f32_32x32x16_bf16 v[192:207], v[144:147], v[224:227], v[192:207]
    v_lshl_add_u32 v12, v13, 9, v12
    v_bfe_u32 v13, v1, 4, 1
    v_mfma_f32_32x32x16_bf16 v[192:207], v[148:151], v[228:231], v[192:207]
    v_lshl_add_u32 v12, v13, 3, v12
    v_add_u32 v22, s25, v12
    v_mfma_f32_32x32x16_bf16 v[240:255], v[152:155], v[232:235], v[240:255]
    v_add_u32 v23, s8, v12
    v_and_b32 v13, 15, v1
    v_mfma_f32_32x32x16_bf16 v[240:255], v[156:159], v[236:239], v[240:255]
    v_lshlrev_b32 v13, 3, v13
    v_sub_u32 v2, v167, v13
    ds_write_b32 v14, v24 offset:8192
    ds_read_b32 v50, v50 offset:8192
    ds_read_b32 v51, v51 offset:8288
    ds_read_b128 v[96:99], v170 offset:14336
    ds_read_b128 v[100:103], v170 offset:15360
    ds_read_b128 v[104:107], v171 offset:14336
    ds_read_b128 v[108:111], v171 offset:15360
    ds_read_b128 v[112:115], v20 offset:14336
    ds_read_b128 v[116:119], v20 offset:15360
    ds_read_b128 v[120:123], v21 offset:14336
    ds_read_b128 v[124:127], v21 offset:15360
    v_mov_b32 v72, v24
    v_add_u32 v73, v24, v30
    v_cndmask_b32 v5, 0, v30, s[12:13]
    s_bitcmp1_b32 s77, 1
    s_cselect_b64 vcc, -1, 0
    s_waitcnt vmcnt(0)
    v_xor_b32 v48, s68, v48
    v_xor_b32 v49, s46, v49
    v_or_b32 v48, v48, v49
    v_cmp_ne_u32 s[86:87], 0, v48
    s_bitcmp0_b32 s77, 0
    s_cbranch_scc1 L_pre1
    buffer_load_dwordx4 v[208:211], v167, s[36:39], s73 offen sc1
    buffer_load_dwordx4 v[212:215], v167, s[36:39], s73 offen offset:256 sc1
    buffer_load_dwordx2 v[216:217], v2, s[36:39], s73 offen offset:512 sc1
    s_cbranch_vccz L_pre1
    buffer_load_dwordx4 v[224:227], v167, s[36:39], s74 offen sc1
    buffer_load_dwordx4 v[228:231], v167, s[36:39], s74 offen offset:256 sc1
    buffer_load_dwordx2 v[232:233], v2, s[36:39], s74 offen offset:512 sc1
L_pre1:
    v_mov_b32 v184, v24
    v_mov_b32 v185, v73
    s_barrier
    ds_read_b64_tr_b16 v[136:137], v61 offset:0
    ds_read_b64_tr_b16 v[138:139], v61 offset:2048
    ds_read_b64_tr_b16 v[152:153], v63 offset:0
    ds_read_b64_tr_b16 v[154:155], v63 offset:2048
    ds_read_b64_tr_b16 v[128:129], v60 offset:0
    ds_read_b64_tr_b16 v[130:131], v60 offset:2048
    ds_read_b64_tr_b16 v[144:145], v62 offset:0
    ds_read_b64_tr_b16 v[146:147], v62 offset:2048
    s_waitcnt lgkmcnt(6)
    v_mfma_f32_32x32x16_bf16 v[240:255], v[136:139], v[104:107], v[240:255]
    s_waitcnt lgkmcnt(4)
    v_mfma_f32_32x32x16_bf16 v[240:255], v[152:155], v[120:123], v[240:255]
    s_waitcnt lgkmcnt(2)
    v_mfma_f32_32x32x16_bf16 v[192:207], v[128:131], v[96:99], v[192:207]
    s_waitcnt lgkmcnt(0)
    v_mfma_f32_32x32x16_bf16 v[192:207], v[144:147], v[112:115], v[192:207]
    s_barrier
    ds_read_b64_tr_b16 v[140:141], v61 offset:4096
    ds_read_b64_tr_b16 v[142:143], v61 offset:6144
    ds_read_b64_tr_b16 v[156:157], v63 offset:4096
    ds_read_b64_tr_b16 v[158:159], v63 offset:6144
    ds_read_b64_tr_b16 v[132:133], v60 offset:4096
    ds_read_b64_tr_b16 v[134:135], v60 offset:6144
    ds_read_b64_tr_b16 v[148:149], v62 offset:4096
    ds_read_b64_tr_b16 v[150:151], v62 offset:6144
    s_waitcnt lgkmcnt(6)
    v_mfma_f32_32x32x16_bf16 v[240:255], v[140:143], v[108:111], v[240:255]
    s_waitcnt lgkmcnt(4)
    v_mfma_f32_32x32x16_bf16 v[240:255], v[156:159], v[124:127], v[240:255]
    s_waitcnt lgkmcnt(2)
    v_mfma_f32_32x32x16_bf16 v[192:207], v[132:135], v[100:103], v[192:207]
    s_waitcnt lgkmcnt(0)
    v_mfma_f32_32x32x16_bf16 v[192:207], v[148:151], v[116:119], v[192:207]
    s_add_u32 s60, s59, 2560
    s_cmp_lg_u64 s[86:87], 0
    s_cbranch_scc1 L_far1
    s_nop 4
    v_cvt_pk_bf16_f32 v176, v240, v241
    v_cvt_pk_bf16_f32 v177, v242, v243
    v_cvt_pk_bf16_f32 v178, v244, v245
    v_cvt_pk_bf16_f32 v179, v246, v247
    v_cvt_pk_bf16_f32 v180, v248, v249
    v_cvt_pk_bf16_f32 v181, v250, v251
    v_cvt_pk_bf16_f32 v182, v252, v253
    v_cvt_pk_bf16_f32 v183, v254, v255
    s_mov_b64 exec, s[10:11]
    buffer_store_dwordx4 v[176:179], v0, s[36:39], s60 offen
    v_add3_u32 v185, v185, v176, v177
    v_add3_u32 v186, v178, v179, v180
    buffer_store_dwordx4 v[180:183], v0, s[36:39], s60 offen offset:256
    v_add3_u32 v185, v185, v181, v182
    v_add3_u32 v185, v185, v183, v186
    buffer_store_dwordx2 v[184:185], v7, s[36:39], s60 offen offset:512
    s_mov_b64 exec, -1
L_sent1:
    ds_write_b128 v166, v[176:179] offset:4096
    ds_write_b128 v166, v[180:183] offset:5120
    s_branch L_pub
L_far1:
    s_nop 4
    v_cvt_pk_bf16_f32 v176, v240, v241
    v_cvt_pk_bf16_f32 v177, v242, v243
    v_cvt_pk_bf16_f32 v178, v244, v245
    v_cvt_pk_bf16_f32 v179, v246, v247
    v_cvt_pk_bf16_f32 v180, v248, v249
    v_cvt_pk_bf16_f32 v181, v250, v251
    v_cvt_pk_bf16_f32 v182, v252, v253
    v_cvt_pk_bf16_f32 v183, v254, v255
    s_mov_b64 exec, s[10:11]
    buffer_store_dwordx4 v[176:179], v0, s[36:39], s60 offen sc1
    v_add3_u32 v185, v185, v176, v177
    v_add3_u32 v186, v178, v179, v180
    buffer_store_dwordx4 v[180:183], v0, s[36:39], s60 offen offset:256 sc1
    v_add3_u32 v185, v185, v181, v182
    v_add3_u32 v185, v185, v183, v186
    buffer_store_dwordx2 v[184:185], v7, s[36:39], s60 offen offset:512 sc1
    s_mov_b64 exec, -1
    s_branch L_sent1
L_far0:
    s_nop 9
    v_cvt_pk_bf16_f32 v64, v192, v193
    v_cvt_pk_bf16_f32 v65, v194, v195
    v_cvt_pk_bf16_f32 v66, v196, v197
    v_cvt_pk_bf16_f32 v67, v198, v199
    v_cvt_pk_bf16_f32 v68, v200, v201
    v_cvt_pk_bf16_f32 v69, v202, v203
    v_cvt_pk_bf16_f32 v70, v204, v205
    v_cvt_pk_bf16_f32 v71, v206, v207
    s_mov_b64 exec, s[10:11]
    buffer_store_dwordx4 v[64:67], v0, s[36:39], s59 offen sc1
    v_add3_u32 v73, v73, v64, v65
    v_add3_u32 v74, v66, v67, v68
    buffer_store_dwordx4 v[68:71], v0, s[36:39], s59 offen offset:256 sc1
    v_add3_u32 v73, v73, v69, v70
    v_add3_u32 v73, v73, v71, v74
    buffer_store_dwordx2 v[72:73], v7, s[36:39], s59 offen offset:512 sc1
    s_mov_b64 exec, -1
    s_branch L_sent0
.p2align 3
.type plan_tab,@object
plan_tab:
    .long 0, 3604, 3604, 7208, 7208, 10812, 10812, 14416
    .long 14416, 18020, 18020, 21624, 21624, 25228, 25228, 28832
    .long 28832, 32436, 32436, 36040, 36040, 39644, 39644, 43248
    .long 43248, 46852, 46852, 50456, 50456, 54060, 54060, 57664
    .long 57664, 61600, 61600, 65536, 0, 4315, 4315, 8629
    .long 8629, 13371, 13371, 18114, 18114, 22856, 22856, 27598
    .long 27598, 32340, 32340, 37083, 37083, 41825, 41825, 46567
    .long 46567, 51309, 51309, 56052, 56052, 60794, 60794, 65536
    .long 0, 4096, 4096, 8192, 8192, 12288, 12288, 16384
    .long 16384, 20480, 20480, 24576, 24576, 28672, 28672, 32768
    .long 32768, 36864, 36864, 40960, 40960, 45056, 45056, 49152
    .long 49152, 53248, 53248, 57344, 57344, 61440, 61440, 65536
    .long 0, 4096, 4096, 8192, 8192, 12288, 12288, 16384
    .long 16384, 20480, 20480, 24576, 24576, 28672, 28672, 32768
    .long 32768, 36864, 36864, 40960, 40960, 45056, 45056, 49152
    .long 49152, 53248, 53248, 57344, 57344, 61440, 61440, 65536
    .long 0, 3663, 3663, 7327, 7327, 10990, 10990, 14654
    .long 14654, 18317, 18317, 21980, 21980, 25644, 25644, 29307
    .long 29307, 32971, 32971, 36634, 36634, 40298, 40298, 43961
    .long 43961, 47624, 47624, 51288, 51288, 54951, 54951, 58615
    .long 58615, 62075, 62075, 65536, 0, 4901, 4901, 9803
    .long 9803, 14447, 14447, 19092, 19092, 23736, 23736, 28381
    .long 28381, 33025, 33025, 37669, 37669, 42314, 42314, 46958
    .long 46958, 51603, 51603, 56247, 56247, 60892, 60892, 65536
    .long 0, 5461, 5461, 10923, 10923, 16384, 16384, 21845
    .long 21845, 27307, 27307, 32768, 32768, 38229, 38229, 43691
    .long 43691, 49152, 49152, 54613, 54613, 60075, 60075, 65536
    .long 0, 3277, 3277, 6554, 6554, 9830, 9830, 13107
    .long 13107, 16384, 16384, 19661, 19661, 22938, 22938, 26214
    .long 26214, 29491, 29491, 32768, 32768, 36045, 36045, 39322
    .long 39322, 42598, 42598, 45875, 45875, 49152, 49152, 52429
    .long 52429, 55706, 55706, 58982, 58982, 62259, 62259, 65536
.size plan_tab, 1024
.section .rodata,"a"
.p2align 6
.amdhsa_kernel standalone__paged_block_table_kv_pagedattention__sampling_kernel
  .amdhsa_next_free_vgpr 256
  .amdhsa_next_free_sgpr 102
  .amdhsa_accum_offset 256
  .amdhsa_group_segment_fixed_size 0
  .amdhsa_kernarg_size 64
  .amdhsa_user_sgpr_count 2
  .amdhsa_user_sgpr_kernarg_segment_ptr 1
  .amdhsa_system_sgpr_workgroup_id_x 1
.end_amdhsa_kernel
```
